```python
import torch

def _softmax(x, axis=-1):
    return torch.softmax(x, dim=axis)
def _gelu(x):
    return torch.nn.functional.gelu(x, approximate="tanh")
def _silu(x):
    return torch.nn.functional.silu(x)
def _sigmoid(x):
    return torch.sigmoid(x)
def _layernorm(x, axis=-1, eps=1e-5):
    m = x.mean(dim=axis, keepdim=True)
    v = x.var(dim=axis, keepdim=True, unbiased=False)
    return (x - m) / torch.sqrt(v + eps)
def _scatter_add(tgt, idx, src, axis=0):
    return tgt.clone().index_add_(axis, idx, src)
def _segment_sum(src, seg, n):
    out = torch.zeros((n,) + src.shape[1:], dtype=src.dtype)
    return out.index_add_(0, seg, src)
def _pad(x, pw):
    flat = tuple(v for pair in reversed(pw) for v in pair)
    return torch.nn.functional.pad(x, flat)

kernel_name = 'standalone__swiglu_ffn__sampling'

def setup_inputs():

    _w = (lambda a: (lambda t: t.to(torch.bfloat16) if t.is_floating_point() else t)(torch.as_tensor(a)))
    B, S, D, F = 16, 16, 1024, 3584
    return {
        "x": _w((lambda *s: torch.randn(*s, dtype=torch.bfloat16) * 0.05)(B, S, D)),
        "w_gate": _w((lambda *s: torch.randn(*s, dtype=torch.bfloat16) * 0.05)(D, F)),
        "w_up": _w((lambda *s: torch.randn(*s, dtype=torch.bfloat16) * 0.05)(D, F)),
        "w_down": _w((lambda *s: torch.randn(*s, dtype=torch.bfloat16) * 0.05)(F, D)),
    }

def reference(x, w_gate, w_up, w_down):
    g = _silu(x @ w_gate)
    u = x @ w_up
    return (g * u) @ w_down
```

```asm
; @launch kernel=ffn_up_kernel grid=(224,1,1) block=(256,1,1) lds=147456
; @launch kernel=ffn_down_kernel grid=(256,1,1) block=(256,1,1) lds=163840
.amdgcn_target "amdgcn-amd-amdhsa--gfx950"
.text

.globl ffn_up_kernel
.p2align 8
.type ffn_up_kernel,@function
ffn_up_kernel:
  s_cmp_ge_u32 s2, 224
  s_cbranch_scc1 L_k1_end
  s_load_dwordx4 s[24:27], s[0:1], 0
  s_load_dwordx4 s[28:31], s[0:1], 16
  s_load_dwordx2 s[22:23], s[0:1], 48
  s_and_b32 s32, s2, 7
  s_lshr_b32 s33, s2, 3
  s_and_b32 s34, s33, 3
  s_lshr_b32 s35, s2, 5
  s_lshl_b32 s36, s35, 3
  s_add_u32 s36, s36, s32
  s_mul_i32 s52, s34, 4
  s_lshl_b32 s37, s34, 6
  s_lshl_b32 s38, s36, 6
  v_and_b32 v1, 63, v0
  v_lshrrev_b32 v2, 6, v0
  v_lshrrev_b32 v3, 3, v1
  v_readfirstlane_b32 s39, v2
  v_and_b32 v4, 7, v1
  s_lshl_b32 s40, s39, 4
  s_add_u32 s41, s40, s37
  v_add_u32 v5, s41, v3
  v_lshlrev_b32 v5, 11, v5
  v_xor_b32 v6, v4, v3
  v_lshlrev_b32 v6, 4, v6
  v_add_u32 v10, v5, v6
  v_add_u32 v11, 16384, v10
  v_add_u32 v5, s40, v3
  s_movk_i32 s42, 7168
  v_mul_lo_u32 v5, v5, s42
  s_lshl_b32 s43, s38, 1
  v_add_u32 v5, s43, v5
  v_and_b32 v6, 3, v3
  v_xor_b32 v7, v4, v6
  v_lshlrev_b32 v7, 4, v7
  v_add_u32 v12, v5, v7
  v_xor_b32 v7, 4, v6
  v_xor_b32 v7, v4, v7
  v_lshlrev_b32 v7, 4, v7
  v_add_u32 v13, v5, v7
  v_add_u32 v13, 57344, v13
  s_lshl_b32 s44, s39, 11
  s_lshl_b32 s45, s33, 2
  s_add_u32 s45, s45, s39
  s_lshl_b32 s46, s45, 13
  v_lshlrev_b32 v5, 7, v1
  v_add_u32 v28, s46, v5
  s_lshl_b32 s46, s45, 5
  v_lshrrev_b32 v5, 1, v1
  v_add_u32 v5, s46, v5
  v_lshlrev_b32 v5, 11, v5
  v_and_b32 v6, 1, v1
  v_lshlrev_b32 v6, 7, v6
  v_add_u32 v5, v5, v6
  s_lshl_b32 s46, s32, 8
  v_add_u32 v29, s46, v5
  s_waitcnt lgkmcnt(0)
  s_mov_b32 s4, s24
  s_and_b32 s5, s25, 0xffff
  s_mov_b32 s6, 524288
  s_mov_b32 s7, 0x00020000
  s_mov_b32 s8, s26
  s_and_b32 s9, s27, 0xffff
  s_mov_b32 s10, 7340032
  s_mov_b32 s11, 0x00020000
  s_mov_b32 s12, s28
  s_and_b32 s13, s29, 0xffff
  s_mov_b32 s14, 7340032
  s_mov_b32 s15, 0x00020000
  buffer_load_dword v30, v28, s[4:7], 0 offen
  s_add_u32 s53, s52, 0
  s_and_b32 s53, s53, 15
  s_lshl_b32 s48, s53, 7
  s_mul_i32 s49, s53, 458752
  s_add_u32 m0, s44, 8192
  s_nop 0
  buffer_load_dwordx4 v12, s[8:11], s49 offen lds
  s_add_u32 m0, s44, 9216
  s_nop 0
  buffer_load_dwordx4 v13, s[8:11], s49 offen lds
  s_add_u32 m0, s44, 16384
  s_nop 0
  buffer_load_dwordx4 v12, s[12:15], s49 offen lds
  s_add_u32 m0, s44, 17408
  s_nop 0
  buffer_load_dwordx4 v13, s[12:15], s49 offen lds
  s_add_u32 m0, s44, 0
  s_nop 0
  buffer_load_dwordx4 v10, s[4:7], s48 offen lds
  s_add_u32 m0, s44, 1024
  s_nop 0
  buffer_load_dwordx4 v11, s[4:7], s48 offen lds
  s_mov_b32 s16, s22
  s_and_b32 s17, s23, 0xffff
  s_mov_b32 s18, 1835008
  s_mov_b32 s19, 0x00020000
  s_mov_b32 s24, s30
  s_and_b32 s25, s31, 0xffff
  s_mov_b32 s26, 7340032
  s_mov_b32 s27, 0x00020000
  s_lshr_b32 s45, s39, 1
  s_and_b32 s46, s39, 1
  v_and_b32 v5, 15, v1
  s_lshl_b32 s47, s45, 5
  v_add_u32 v5, s47, v5
  v_lshlrev_b32 v5, 7, v5
  v_lshrrev_b32 v6, 4, v1
  v_xor_b32 v7, v6, v4
  v_lshlrev_b32 v8, 4, v7
  v_add_u32 v14, v5, v8
  v_xor_b32 v7, 4, v7
  v_lshlrev_b32 v8, 4, v7
  v_add_u32 v15, v5, v8
  v_lshrrev_b32 v7, 2, v1
  v_and_b32 v7, 3, v7
  v_lshlrev_b32 v8, 3, v6
  v_add_u32 v8, v8, v7
  v_lshlrev_b32 v8, 7, v8
  v_and_b32 v9, 1, v1
  v_lshlrev_b32 v9, 3, v9
  v_add_u32 v8, v8, v9
  v_add_u32 v8, 8192, v8
  v_and_b32 v9, 1, v6
  v_lshlrev_b32 v9, 2, v9
  v_or_b32 v9, v9, v7
  v_lshrrev_b32 v5, 1, v1
  v_and_b32 v5, 1, v5
  s_lshl_b32 s47, s46, 2
  v_add_u32 v5, s47, v5
  v_xor_b32 v7, v5, v9
  v_lshlrev_b32 v7, 4, v7
  v_add_u32 v16, v8, v7
  v_add_u32 v5, 2, v5
  v_xor_b32 v7, v5, v9
  v_lshlrev_b32 v7, 4, v7
  v_add_u32 v17, v8, v7
  v_add_u32 v18, 49152, v14
  v_add_u32 v22, 98304, v14
  v_add_u32 v19, 49152, v15
  v_add_u32 v23, 98304, v15
  v_add_u32 v20, 49152, v16
  v_add_u32 v24, 98304, v16
  v_add_u32 v21, 49152, v17
  v_add_u32 v25, 98304, v17
  v_mov_b32 v32, 0
  v_mov_b32 v33, 0
  v_mov_b32 v34, 0
  v_mov_b32 v35, 0
  v_mov_b32 v36, 0
  v_mov_b32 v37, 0
  v_mov_b32 v38, 0
  v_mov_b32 v39, 0
  v_mov_b32 v40, 0
  v_mov_b32 v41, 0
  v_mov_b32 v42, 0
  v_mov_b32 v43, 0
  v_mov_b32 v44, 0
  v_mov_b32 v45, 0
  v_mov_b32 v46, 0
  v_mov_b32 v47, 0
  v_mov_b32 v48, 0
  v_mov_b32 v49, 0
  v_mov_b32 v50, 0
  v_mov_b32 v51, 0
  v_mov_b32 v52, 0
  v_mov_b32 v53, 0
  v_mov_b32 v54, 0
  v_mov_b32 v55, 0
  v_mov_b32 v56, 0
  v_mov_b32 v57, 0
  v_mov_b32 v58, 0
  v_mov_b32 v59, 0
  v_mov_b32 v60, 0
  v_mov_b32 v61, 0
  v_mov_b32 v62, 0
  v_mov_b32 v63, 0
  s_add_u32 s53, s52, 1
  s_and_b32 s53, s53, 15
  s_lshl_b32 s48, s53, 7
  s_mul_i32 s49, s53, 458752
  s_add_u32 m0, s44, 32768
  s_nop 0
  buffer_load_dwordx4 v12, s[8:11], s49 offen lds
  s_add_u32 m0, s44, 33792
  s_nop 0
  buffer_load_dwordx4 v13, s[8:11], s49 offen lds
  s_add_u32 m0, s44, 40960
  s_nop 0
  buffer_load_dwordx4 v12, s[12:15], s49 offen lds
  s_add_u32 m0, s44, 41984
  s_nop 0
  buffer_load_dwordx4 v13, s[12:15], s49 offen lds
  s_add_u32 m0, s44, 24576
  s_nop 0
  buffer_load_dwordx4 v10, s[4:7], s48 offen lds
  s_add_u32 m0, s44, 25600
  s_nop 0
  buffer_load_dwordx4 v11, s[4:7], s48 offen lds
  s_add_u32 s53, s52, 2
  s_and_b32 s53, s53, 15
  s_lshl_b32 s48, s53, 7
  s_mul_i32 s49, s53, 458752
  s_add_u32 m0, s44, 57344
  s_nop 0
  buffer_load_dwordx4 v12, s[8:11], s49 offen lds
  s_add_u32 m0, s44, 58368
  s_nop 0
  buffer_load_dwordx4 v13, s[8:11], s49 offen lds
  s_add_u32 m0, s44, 65536
  s_nop 0
  buffer_load_dwordx4 v12, s[12:15], s49 offen lds
  s_add_u32 m0, s44, 66560
  s_nop 0
  buffer_load_dwordx4 v13, s[12:15], s49 offen lds
  s_add_u32 m0, s44, 49152
  s_nop 0
  buffer_load_dwordx4 v10, s[4:7], s48 offen lds
  s_add_u32 m0, s44, 50176
  s_nop 0
  buffer_load_dwordx4 v11, s[4:7], s48 offen lds
  s_waitcnt vmcnt(12)
  s_barrier
  ds_read_b128 v[64:67], v14 offset:0
  ds_read_b128 v[68:71], v14 offset:2048
  ds_read_b64_tr_b16 v[72:73], v16 offset:0
  ds_read_b64_tr_b16 v[74:75], v16 offset:512
  ds_read_b64_tr_b16 v[76:77], v17 offset:0
  ds_read_b64_tr_b16 v[78:79], v17 offset:512
  ds_read_b64_tr_b16 v[80:81], v16 offset:8192
  ds_read_b64_tr_b16 v[82:83], v16 offset:8704
  ds_read_b64_tr_b16 v[84:85], v17 offset:8192
  ds_read_b64_tr_b16 v[86:87], v17 offset:8704
  ds_read_b128 v[88:91], v15 offset:0
  ds_read_b128 v[92:95], v15 offset:2048
  ds_read_b64_tr_b16 v[96:97], v16 offset:4096
  ds_read_b64_tr_b16 v[98:99], v16 offset:4608
  ds_read_b64_tr_b16 v[100:101], v17 offset:4096
  ds_read_b64_tr_b16 v[102:103], v17 offset:4608
  ds_read_b64_tr_b16 v[104:105], v16 offset:12288
  ds_read_b64_tr_b16 v[106:107], v16 offset:12800
  ds_read_b64_tr_b16 v[108:109], v17 offset:12288
  ds_read_b64_tr_b16 v[110:111], v17 offset:12800
  s_waitcnt vmcnt(6) lgkmcnt(0)
  s_barrier
  v_mfma_f32_16x16x32_bf16 v[32:35], v[72:75], v[64:67], v[32:35]
  ds_read_b128 v[112:115], v14 offset:24576
  s_add_u32 s53, s52, 3
  s_and_b32 s53, s53, 15
  s_lshl_b32 s48, s53, 7
  s_mul_i32 s49, s53, 458752
  s_add_u32 m0, s44, 81920
  s_nop 0
  buffer_load_dwordx4 v12, s[8:11], s49 offen lds
  v_mfma_f32_16x16x32_bf16 v[40:43], v[72:75], v[68:71], v[40:43]
  ds_read_b128 v[116:119], v14 offset:26624
  s_add_u32 m0, s44, 82944
  s_nop 0
  buffer_load_dwordx4 v13, s[8:11], s49 offen lds
  v_mfma_f32_16x16x32_bf16 v[36:39], v[76:79], v[64:67], v[36:39]
  ds_read_b64_tr_b16 v[120:121], v16 offset:24576
  ds_read_b64_tr_b16 v[122:123], v16 offset:25088
  v_mfma_f32_16x16x32_bf16 v[44:47], v[76:79], v[68:71], v[44:47]
  s_add_u32 m0, s44, 90112
  s_nop 0
  buffer_load_dwordx4 v12, s[12:15], s49 offen lds
  ds_read_b64_tr_b16 v[124:125], v17 offset:24576
  v_mfma_f32_16x16x32_bf16 v[48:51], v[80:83], v[64:67], v[48:51]
  ds_read_b64_tr_b16 v[126:127], v17 offset:25088
  s_add_u32 m0, s44, 91136
  s_nop 0
  buffer_load_dwordx4 v13, s[12:15], s49 offen lds
  v_mfma_f32_16x16x32_bf16 v[56:59], v[80:83], v[68:71], v[56:59]
  ds_read_b64_tr_b16 v[128:129], v16 offset:32768
  s_add_u32 m0, s44, 73728
  s_nop 0
  buffer_load_dwordx4 v10, s[4:7], s48 offen lds
  v_mfma_f32_16x16x32_bf16 v[52:55], v[84:87], v[64:67], v[52:55]
  ds_read_b64_tr_b16 v[130:131], v16 offset:33280
  ds_read_b64_tr_b16 v[132:133], v17 offset:32768
  v_mfma_f32_16x16x32_bf16 v[60:63], v[84:87], v[68:71], v[60:63]
  s_add_u32 m0, s44, 74752
  s_nop 0
  buffer_load_dwordx4 v11, s[4:7], s48 offen lds
  ds_read_b64_tr_b16 v[134:135], v17 offset:33280
  v_mfma_f32_16x16x32_bf16 v[32:35], v[96:99], v[88:91], v[32:35]
  ds_read_b128 v[136:139], v15 offset:24576
  s_add_u32 s53, s52, 4
  s_and_b32 s53, s53, 15
  s_lshl_b32 s48, s53, 7
  s_mul_i32 s49, s53, 458752
  s_add_u32 m0, s44, 106496
  s_nop 0
  buffer_load_dwordx4 v12, s[8:11], s49 offen lds
  v_mfma_f32_16x16x32_bf16 v[40:43], v[96:99], v[92:95], v[40:43]
  ds_read_b128 v[140:143], v15 offset:26624
  s_add_u32 m0, s44, 107520
  s_nop 0
  buffer_load_dwordx4 v13, s[8:11], s49 offen lds
  v_mfma_f32_16x16x32_bf16 v[36:39], v[100:103], v[88:91], v[36:39]
  ds_read_b64_tr_b16 v[144:145], v16 offset:28672
  ds_read_b64_tr_b16 v[146:147], v16 offset:29184
  v_mfma_f32_16x16x32_bf16 v[44:47], v[100:103], v[92:95], v[44:47]
  s_add_u32 m0, s44, 114688
  s_nop 0
  buffer_load_dwordx4 v12, s[12:15], s49 offen lds
  ds_read_b64_tr_b16 v[148:149], v17 offset:28672
  v_mfma_f32_16x16x32_bf16 v[48:51], v[104:107], v[88:91], v[48:51]
  ds_read_b64_tr_b16 v[150:151], v17 offset:29184
  s_add_u32 m0, s44, 115712
  s_nop 0
  buffer_load_dwordx4 v13, s[12:15], s49 offen lds
  v_mfma_f32_16x16x32_bf16 v[56:59], v[104:107], v[92:95], v[56:59]
  ds_read_b64_tr_b16 v[152:153], v16 offset:36864
  s_add_u32 m0, s44, 98304
  s_nop 0
  buffer_load_dwordx4 v10, s[4:7], s48 offen lds
  v_mfma_f32_16x16x32_bf16 v[52:55], v[108:111], v[88:91], v[52:55]
  ds_read_b64_tr_b16 v[154:155], v16 offset:37376
  ds_read_b64_tr_b16 v[156:157], v17 offset:36864
  v_mfma_f32_16x16x32_bf16 v[60:63], v[108:111], v[92:95], v[60:63]
  s_add_u32 m0, s44, 99328
  s_nop 0
  buffer_load_dwordx4 v11, s[4:7], s48 offen lds
  ds_read_b64_tr_b16 v[158:159], v17 offset:37376
  s_waitcnt vmcnt(12) lgkmcnt(0)
  s_barrier
  v_mfma_f32_16x16x32_bf16 v[32:35], v[120:123], v[112:115], v[32:35]
  ds_read_b128 v[64:67], v18 offset:0
  s_add_u32 s53, s52, 5
  s_and_b32 s53, s53, 15
  s_lshl_b32 s48, s53, 7
  s_mul_i32 s49, s53, 458752
  s_add_u32 m0, s44, 131072
  s_nop 0
  buffer_load_dwordx4 v12, s[8:11], s49 offen lds
  v_mfma_f32_16x16x32_bf16 v[40:43], v[120:123], v[116:119], v[40:43]
  ds_read_b128 v[68:71], v18 offset:2048
  s_add_u32 m0, s44, 132096
  s_nop 0
  buffer_load_dwordx4 v13, s[8:11], s49 offen lds
  v_mfma_f32_16x16x32_bf16 v[36:39], v[124:127], v[112:115], v[36:39]
  ds_read_b64_tr_b16 v[72:73], v20 offset:0
  ds_read_b64_tr_b16 v[74:75], v20 offset:512
  v_mfma_f32_16x16x32_bf16 v[44:47], v[124:127], v[116:119], v[44:47]
  s_add_u32 m0, s44, 139264
  s_nop 0
  buffer_load_dwordx4 v12, s[12:15], s49 offen lds
  ds_read_b64_tr_b16 v[76:77], v21 offset:0
  v_mfma_f32_16x16x32_bf16 v[48:51], v[128:131], v[112:115], v[48:51]
  ds_read_b64_tr_b16 v[78:79], v21 offset:512
  s_add_u32 m0, s44, 140288
  s_nop 0
  buffer_load_dwordx4 v13, s[12:15], s49 offen lds
  v_mfma_f32_16x16x32_bf16 v[56:59], v[128:131], v[116:119], v[56:59]
  ds_read_b64_tr_b16 v[80:81], v20 offset:8192
  s_add_u32 m0, s44, 122880
  s_nop 0
  buffer_load_dwordx4 v10, s[4:7], s48 offen lds
  v_mfma_f32_16x16x32_bf16 v[52:55], v[132:135], v[112:115], v[52:55]
  ds_read_b64_tr_b16 v[82:83], v20 offset:8704
  ds_read_b64_tr_b16 v[84:85], v21 offset:8192
  v_mfma_f32_16x16x32_bf16 v[60:63], v[132:135], v[116:119], v[60:63]
  s_add_u32 m0, s44, 123904
  s_nop 0
  buffer_load_dwordx4 v11, s[4:7], s48 offen lds
  ds_read_b64_tr_b16 v[86:87], v21 offset:8704
  v_mfma_f32_16x16x32_bf16 v[32:35], v[144:147], v[136:139], v[32:35]
  ds_read_b128 v[88:91], v19 offset:0
  s_add_u32 s53, s52, 6
  s_and_b32 s53, s53, 15
  s_lshl_b32 s48, s53, 7
  s_mul_i32 s49, s53, 458752
  s_add_u32 m0, s44, 8192
  s_nop 0
  buffer_load_dwordx4 v12, s[8:11], s49 offen lds
  v_mfma_f32_16x16x32_bf16 v[40:43], v[144:147], v[140:143], v[40:43]
  ds_read_b128 v[92:95], v19 offset:2048
  s_add_u32 m0, s44, 9216
  s_nop 0
  buffer_load_dwordx4 v13, s[8:11], s49 offen lds
  v_mfma_f32_16x16x32_bf16 v[36:39], v[148:151], v[136:139], v[36:39]
  ds_read_b64_tr_b16 v[96:97], v20 offset:4096
  ds_read_b64_tr_b16 v[98:99], v20 offset:4608
  v_mfma_f32_16x16x32_bf16 v[44:47], v[148:151], v[140:143], v[44:47]
  s_add_u32 m0, s44, 16384
  s_nop 0
  buffer_load_dwordx4 v12, s[12:15], s49 offen lds
  ds_read_b64_tr_b16 v[100:101], v21 offset:4096
  v_mfma_f32_16x16x32_bf16 v[48:51], v[152:155], v[136:139], v[48:51]
  ds_read_b64_tr_b16 v[102:103], v21 offset:4608
  s_add_u32 m0, s44, 17408
  s_nop 0
  buffer_load_dwordx4 v13, s[12:15], s49 offen lds
  v_mfma_f32_16x16x32_bf16 v[56:59], v[152:155], v[140:143], v[56:59]
  ds_read_b64_tr_b16 v[104:105], v20 offset:12288
  s_add_u32 m0, s44, 0
  s_nop 0
  buffer_load_dwordx4 v10, s[4:7], s48 offen lds
  v_mfma_f32_16x16x32_bf16 v[52:55], v[156:159], v[136:139], v[52:55]
  ds_read_b64_tr_b16 v[106:107], v20 offset:12800
  ds_read_b64_tr_b16 v[108:109], v21 offset:12288
  v_mfma_f32_16x16x32_bf16 v[60:63], v[156:159], v[140:143], v[60:63]
  s_add_u32 m0, s44, 1024
  s_nop 0
  buffer_load_dwordx4 v11, s[4:7], s48 offen lds
  ds_read_b64_tr_b16 v[110:111], v21 offset:12800
  s_waitcnt vmcnt(18) lgkmcnt(0)
  s_barrier
  v_mfma_f32_16x16x32_bf16 v[32:35], v[72:75], v[64:67], v[32:35]
  ds_read_b128 v[112:115], v18 offset:24576
  s_add_u32 s53, s52, 7
  s_and_b32 s53, s53, 15
  s_lshl_b32 s48, s53, 7
  s_mul_i32 s49, s53, 458752
  s_add_u32 m0, s44, 32768
  s_nop 0
  buffer_load_dwordx4 v12, s[8:11], s49 offen lds
  v_mfma_f32_16x16x32_bf16 v[40:43], v[72:75], v[68:71], v[40:43]
  ds_read_b128 v[116:119], v18 offset:26624
  ds_read_b64_tr_b16 v[120:121], v20 offset:24576
  v_mfma_f32_16x16x32_bf16 v[36:39], v[76:79], v[64:67], v[36:39]
  ds_read_b64_tr_b16 v[122:123], v20 offset:25088
  v_mfma_f32_16x16x32_bf16 v[44:47], v[76:79], v[68:71], v[44:47]
  s_add_u32 m0, s44, 33792
  s_nop 0
  buffer_load_dwordx4 v13, s[8:11], s49 offen lds
  ds_read_b64_tr_b16 v[124:125], v21 offset:24576
  v_mfma_f32_16x16x32_bf16 v[48:51], v[80:83], v[64:67], v[48:51]
  ds_read_b64_tr_b16 v[126:127], v21 offset:25088
  ds_read_b64_tr_b16 v[128:129], v20 offset:32768
  v_mfma_f32_16x16x32_bf16 v[56:59], v[80:83], v[68:71], v[56:59]
  s_add_u32 m0, s44, 40960
  s_nop 0
  buffer_load_dwordx4 v12, s[12:15], s49 offen lds
  v_mfma_f32_16x16x32_bf16 v[52:55], v[84:87], v[64:67], v[52:55]
  ds_read_b64_tr_b16 v[130:131], v20 offset:33280
  ds_read_b64_tr_b16 v[132:133], v21 offset:32768
  v_mfma_f32_16x16x32_bf16 v[60:63], v[84:87], v[68:71], v[60:63]
  ds_read_b64_tr_b16 v[134:135], v21 offset:33280
  v_mfma_f32_16x16x32_bf16 v[32:35], v[96:99], v[88:91], v[32:35]
  ds_read_b128 v[136:139], v19 offset:24576
  s_add_u32 m0, s44, 41984
  s_nop 0
  buffer_load_dwordx4 v13, s[12:15], s49 offen lds
  v_mfma_f32_16x16x32_bf16 v[40:43], v[96:99], v[92:95], v[40:43]
  ds_read_b128 v[140:143], v19 offset:26624
  ds_read_b64_tr_b16 v[144:145], v20 offset:28672
  v_mfma_f32_16x16x32_bf16 v[36:39], v[100:103], v[88:91], v[36:39]
  ds_read_b64_tr_b16 v[146:147], v20 offset:29184
  v_mfma_f32_16x16x32_bf16 v[44:47], v[100:103], v[92:95], v[44:47]
  s_add_u32 m0, s44, 24576
  s_nop 0
  buffer_load_dwordx4 v10, s[4:7], s48 offen lds
  ds_read_b64_tr_b16 v[148:149], v21 offset:28672
  v_mfma_f32_16x16x32_bf16 v[48:51], v[104:107], v[88:91], v[48:51]
  ds_read_b64_tr_b16 v[150:151], v21 offset:29184
  ds_read_b64_tr_b16 v[152:153], v20 offset:36864
  v_mfma_f32_16x16x32_bf16 v[56:59], v[104:107], v[92:95], v[56:59]
  s_add_u32 m0, s44, 25600
  s_nop 0
  buffer_load_dwordx4 v11, s[4:7], s48 offen lds
  v_mfma_f32_16x16x32_bf16 v[52:55], v[108:111], v[88:91], v[52:55]
  ds_read_b64_tr_b16 v[154:155], v20 offset:37376
  ds_read_b64_tr_b16 v[156:157], v21 offset:36864
  v_mfma_f32_16x16x32_bf16 v[60:63], v[108:111], v[92:95], v[60:63]
  ds_read_b64_tr_b16 v[158:159], v21 offset:37376
  s_waitcnt vmcnt(18) lgkmcnt(0)
  s_barrier
  v_mfma_f32_16x16x32_bf16 v[32:35], v[120:123], v[112:115], v[32:35]
  ds_read_b128 v[64:67], v22 offset:0
  s_add_u32 s53, s52, 8
  s_and_b32 s53, s53, 15
  s_lshl_b32 s48, s53, 7
  s_mul_i32 s49, s53, 458752
  s_add_u32 m0, s44, 57344
  s_nop 0
  buffer_load_dwordx4 v12, s[8:11], s49 offen lds
  v_mfma_f32_16x16x32_bf16 v[40:43], v[120:123], v[116:119], v[40:43]
  ds_read_b128 v[68:71], v22 offset:2048
  ds_read_b64_tr_b16 v[72:73], v24 offset:0
  v_mfma_f32_16x16x32_bf16 v[36:39], v[124:127], v[112:115], v[36:39]
  ds_read_b64_tr_b16 v[74:75], v24 offset:512
  v_mfma_f32_16x16x32_bf16 v[44:47], v[124:127], v[116:119], v[44:47]
  s_add_u32 m0, s44, 58368
  s_nop 0
  buffer_load_dwordx4 v13, s[8:11], s49 offen lds
  ds_read_b64_tr_b16 v[76:77], v25 offset:0
  v_mfma_f32_16x16x32_bf16 v[48:51], v[128:131], v[112:115], v[48:51]
  ds_read_b64_tr_b16 v[78:79], v25 offset:512
  ds_read_b64_tr_b16 v[80:81], v24 offset:8192
  v_mfma_f32_16x16x32_bf16 v[56:59], v[128:131], v[116:119], v[56:59]
  s_add_u32 m0, s44, 65536
  s_nop 0
  buffer_load_dwordx4 v12, s[12:15], s49 offen lds
  v_mfma_f32_16x16x32_bf16 v[52:55], v[132:135], v[112:115], v[52:55]
  ds_read_b64_tr_b16 v[82:83], v24 offset:8704
  ds_read_b64_tr_b16 v[84:85], v25 offset:8192
  v_mfma_f32_16x16x32_bf16 v[60:63], v[132:135], v[116:119], v[60:63]
  ds_read_b64_tr_b16 v[86:87], v25 offset:8704
  v_mfma_f32_16x16x32_bf16 v[32:35], v[144:147], v[136:139], v[32:35]
  ds_read_b128 v[88:91], v23 offset:0
  s_add_u32 m0, s44, 66560
  s_nop 0
  buffer_load_dwordx4 v13, s[12:15], s49 offen lds
  v_mfma_f32_16x16x32_bf16 v[40:43], v[144:147], v[140:143], v[40:43]
  ds_read_b128 v[92:95], v23 offset:2048
  ds_read_b64_tr_b16 v[96:97], v24 offset:4096
  v_mfma_f32_16x16x32_bf16 v[36:39], v[148:151], v[136:139], v[36:39]
  ds_read_b64_tr_b16 v[98:99], v24 offset:4608
  v_mfma_f32_16x16x32_bf16 v[44:47], v[148:151], v[140:143], v[44:47]
  s_add_u32 m0, s44, 49152
  s_nop 0
  buffer_load_dwordx4 v10, s[4:7], s48 offen lds
  ds_read_b64_tr_b16 v[100:101], v25 offset:4096
  v_mfma_f32_16x16x32_bf16 v[48:51], v[152:155], v[136:139], v[48:51]
  ds_read_b64_tr_b16 v[102:103], v25 offset:4608
  ds_read_b64_tr_b16 v[104:105], v24 offset:12288
  v_mfma_f32_16x16x32_bf16 v[56:59], v[152:155], v[140:143], v[56:59]
  s_add_u32 m0, s44, 50176
  s_nop 0
  buffer_load_dwordx4 v11, s[4:7], s48 offen lds
  v_mfma_f32_16x16x32_bf16 v[52:55], v[156:159], v[136:139], v[52:55]
  ds_read_b64_tr_b16 v[106:107], v24 offset:12800
  ds_read_b64_tr_b16 v[108:109], v25 offset:12288
  v_mfma_f32_16x16x32_bf16 v[60:63], v[156:159], v[140:143], v[60:63]
  ds_read_b64_tr_b16 v[110:111], v25 offset:12800
  s_waitcnt vmcnt(18) lgkmcnt(0)
  s_barrier
  v_mfma_f32_16x16x32_bf16 v[32:35], v[72:75], v[64:67], v[32:35]
  ds_read_b128 v[112:115], v22 offset:24576
  s_add_u32 s53, s52, 9
  s_and_b32 s53, s53, 15
  s_lshl_b32 s48, s53, 7
  s_mul_i32 s49, s53, 458752
  s_add_u32 m0, s44, 81920
  s_nop 0
  buffer_load_dwordx4 v12, s[8:11], s49 offen lds
  v_mfma_f32_16x16x32_bf16 v[40:43], v[72:75], v[68:71], v[40:43]
  ds_read_b128 v[116:119], v22 offset:26624
  ds_read_b64_tr_b16 v[120:121], v24 offset:24576
  v_mfma_f32_16x16x32_bf16 v[36:39], v[76:79], v[64:67], v[36:39]
  ds_read_b64_tr_b16 v[122:123], v24 offset:25088
  v_mfma_f32_16x16x32_bf16 v[44:47], v[76:79], v[68:71], v[44:47]
  s_add_u32 m0, s44, 82944
  s_nop 0
  buffer_load_dwordx4 v13, s[8:11], s49 offen lds
  ds_read_b64_tr_b16 v[124:125], v25 offset:24576
  v_mfma_f32_16x16x32_bf16 v[48:51], v[80:83], v[64:67], v[48:51]
  ds_read_b64_tr_b16 v[126:127], v25 offset:25088
  ds_read_b64_tr_b16 v[128:129], v24 offset:32768
  v_mfma_f32_16x16x32_bf16 v[56:59], v[80:83], v[68:71], v[56:59]
  s_add_u32 m0, s44, 90112
  s_nop 0
  buffer_load_dwordx4 v12, s[12:15], s49 offen lds
  v_mfma_f32_16x16x32_bf16 v[52:55], v[84:87], v[64:67], v[52:55]
  ds_read_b64_tr_b16 v[130:131], v24 offset:33280
  ds_read_b64_tr_b16 v[132:133], v25 offset:32768
  v_mfma_f32_16x16x32_bf16 v[60:63], v[84:87], v[68:71], v[60:63]
  ds_read_b64_tr_b16 v[134:135], v25 offset:33280
  v_mfma_f32_16x16x32_bf16 v[32:35], v[96:99], v[88:91], v[32:35]
  ds_read_b128 v[136:139], v23 offset:24576
  s_add_u32 m0, s44, 91136
  s_nop 0
  buffer_load_dwordx4 v13, s[12:15], s49 offen lds
  v_mfma_f32_16x16x32_bf16 v[40:43], v[96:99], v[92:95], v[40:43]
  ds_read_b128 v[140:143], v23 offset:26624
  ds_read_b64_tr_b16 v[144:145], v24 offset:28672
  v_mfma_f32_16x16x32_bf16 v[36:39], v[100:103], v[88:91], v[36:39]
  ds_read_b64_tr_b16 v[146:147], v24 offset:29184
  v_mfma_f32_16x16x32_bf16 v[44:47], v[100:103], v[92:95], v[44:47]
  s_add_u32 m0, s44, 73728
  s_nop 0
  buffer_load_dwordx4 v10, s[4:7], s48 offen lds
  ds_read_b64_tr_b16 v[148:149], v25 offset:28672
  v_mfma_f32_16x16x32_bf16 v[48:51], v[104:107], v[88:91], v[48:51]
  ds_read_b64_tr_b16 v[150:151], v25 offset:29184
  ds_read_b64_tr_b16 v[152:153], v24 offset:36864
  v_mfma_f32_16x16x32_bf16 v[56:59], v[104:107], v[92:95], v[56:59]
  s_add_u32 m0, s44, 74752
  s_nop 0
  buffer_load_dwordx4 v11, s[4:7], s48 offen lds
  v_mfma_f32_16x16x32_bf16 v[52:55], v[108:111], v[88:91], v[52:55]
  ds_read_b64_tr_b16 v[154:155], v24 offset:37376
  ds_read_b64_tr_b16 v[156:157], v25 offset:36864
  v_mfma_f32_16x16x32_bf16 v[60:63], v[108:111], v[92:95], v[60:63]
  ds_read_b64_tr_b16 v[158:159], v25 offset:37376
  s_waitcnt vmcnt(18) lgkmcnt(0)
  s_barrier
  v_mfma_f32_16x16x32_bf16 v[32:35], v[120:123], v[112:115], v[32:35]
  ds_read_b128 v[64:67], v14 offset:0
  s_add_u32 s53, s52, 10
  s_and_b32 s53, s53, 15
  s_lshl_b32 s48, s53, 7
  s_mul_i32 s49, s53, 458752
  s_add_u32 m0, s44, 106496
  s_nop 0
  buffer_load_dwordx4 v12, s[8:11], s49 offen lds
  v_mfma_f32_16x16x32_bf16 v[40:43], v[120:123], v[116:119], v[40:43]
  ds_read_b128 v[68:71], v14 offset:2048
  ds_read_b64_tr_b16 v[72:73], v16 offset:0
  v_mfma_f32_16x16x32_bf16 v[36:39], v[124:127], v[112:115], v[36:39]
  ds_read_b64_tr_b16 v[74:75], v16 offset:512
  v_mfma_f32_16x16x32_bf16 v[44:47], v[124:127], v[116:119], v[44:47]
  s_add_u32 m0, s44, 107520
  s_nop 0
  buffer_load_dwordx4 v13, s[8:11], s49 offen lds
  ds_read_b64_tr_b16 v[76:77], v17 offset:0
  v_mfma_f32_16x16x32_bf16 v[48:51], v[128:131], v[112:115], v[48:51]
  ds_read_b64_tr_b16 v[78:79], v17 offset:512
  ds_read_b64_tr_b16 v[80:81], v16 offset:8192
  v_mfma_f32_16x16x32_bf16 v[56:59], v[128:131], v[116:119], v[56:59]
  s_add_u32 m0, s44, 114688
  s_nop 0
  buffer_load_dwordx4 v12, s[12:15], s49 offen lds
  v_mfma_f32_16x16x32_bf16 v[52:55], v[132:135], v[112:115], v[52:55]
  ds_read_b64_tr_b16 v[82:83], v16 offset:8704
  ds_read_b64_tr_b16 v[84:85], v17 offset:8192
  v_mfma_f32_16x16x32_bf16 v[60:63], v[132:135], v[116:119], v[60:63]
  ds_read_b64_tr_b16 v[86:87], v17 offset:8704
  v_mfma_f32_16x16x32_bf16 v[32:35], v[144:147], v[136:139], v[32:35]
  ds_read_b128 v[88:91], v15 offset:0
  s_add_u32 m0, s44, 115712
  s_nop 0
  buffer_load_dwordx4 v13, s[12:15], s49 offen lds
  v_mfma_f32_16x16x32_bf16 v[40:43], v[144:147], v[140:143], v[40:43]
  ds_read_b128 v[92:95], v15 offset:2048
  ds_read_b64_tr_b16 v[96:97], v16 offset:4096
  v_mfma_f32_16x16x32_bf16 v[36:39], v[148:151], v[136:139], v[36:39]
  ds_read_b64_tr_b16 v[98:99], v16 offset:4608
  v_mfma_f32_16x16x32_bf16 v[44:47], v[148:151], v[140:143], v[44:47]
  s_add_u32 m0, s44, 98304
  s_nop 0
  buffer_load_dwordx4 v10, s[4:7], s48 offen lds
  ds_read_b64_tr_b16 v[100:101], v17 offset:4096
  v_mfma_f32_16x16x32_bf16 v[48:51], v[152:155], v[136:139], v[48:51]
  ds_read_b64_tr_b16 v[102:103], v17 offset:4608
  ds_read_b64_tr_b16 v[104:105], v16 offset:12288
  v_mfma_f32_16x16x32_bf16 v[56:59], v[152:155], v[140:143], v[56:59]
  s_add_u32 m0, s44, 99328
  s_nop 0
  buffer_load_dwordx4 v11, s[4:7], s48 offen lds
  v_mfma_f32_16x16x32_bf16 v[52:55], v[156:159], v[136:139], v[52:55]
  ds_read_b64_tr_b16 v[106:107], v16 offset:12800
  ds_read_b64_tr_b16 v[108:109], v17 offset:12288
  v_mfma_f32_16x16x32_bf16 v[60:63], v[156:159], v[140:143], v[60:63]
  ds_read_b64_tr_b16 v[110:111], v17 offset:12800
  s_waitcnt vmcnt(18) lgkmcnt(0)
  s_barrier
  v_mfma_f32_16x16x32_bf16 v[32:35], v[72:75], v[64:67], v[32:35]
  ds_read_b128 v[112:115], v14 offset:24576
  s_add_u32 s53, s52, 11
  s_and_b32 s53, s53, 15
  s_lshl_b32 s48, s53, 7
  s_mul_i32 s49, s53, 458752
  s_add_u32 m0, s44, 131072
  s_nop 0
  buffer_load_dwordx4 v12, s[8:11], s49 offen lds
  v_mfma_f32_16x16x32_bf16 v[40:43], v[72:75], v[68:71], v[40:43]
  ds_read_b128 v[116:119], v14 offset:26624
  ds_read_b64_tr_b16 v[120:121], v16 offset:24576
  v_mfma_f32_16x16x32_bf16 v[36:39], v[76:79], v[64:67], v[36:39]
  ds_read_b64_tr_b16 v[122:123], v16 offset:25088
  v_mfma_f32_16x16x32_bf16 v[44:47], v[76:79], v[68:71], v[44:47]
  s_add_u32 m0, s44, 132096
  s_nop 0
  buffer_load_dwordx4 v13, s[8:11], s49 offen lds
  ds_read_b64_tr_b16 v[124:125], v17 offset:24576
  v_mfma_f32_16x16x32_bf16 v[48:51], v[80:83], v[64:67], v[48:51]
  ds_read_b64_tr_b16 v[126:127], v17 offset:25088
  ds_read_b64_tr_b16 v[128:129], v16 offset:32768
  v_mfma_f32_16x16x32_bf16 v[56:59], v[80:83], v[68:71], v[56:59]
  s_add_u32 m0, s44, 139264
  s_nop 0
  buffer_load_dwordx4 v12, s[12:15], s49 offen lds
  v_mfma_f32_16x16x32_bf16 v[52:55], v[84:87], v[64:67], v[52:55]
  ds_read_b64_tr_b16 v[130:131], v16 offset:33280
  ds_read_b64_tr_b16 v[132:133], v17 offset:32768
  v_mfma_f32_16x16x32_bf16 v[60:63], v[84:87], v[68:71], v[60:63]
  ds_read_b64_tr_b16 v[134:135], v17 offset:33280
  v_mfma_f32_16x16x32_bf16 v[32:35], v[96:99], v[88:91], v[32:35]
  ds_read_b128 v[136:139], v15 offset:24576
  s_add_u32 m0, s44, 140288
  s_nop 0
  buffer_load_dwordx4 v13, s[12:15], s49 offen lds
  v_mfma_f32_16x16x32_bf16 v[40:43], v[96:99], v[92:95], v[40:43]
  ds_read_b128 v[140:143], v15 offset:26624
  ds_read_b64_tr_b16 v[144:145], v16 offset:28672
  v_mfma_f32_16x16x32_bf16 v[36:39], v[100:103], v[88:91], v[36:39]
  ds_read_b64_tr_b16 v[146:147], v16 offset:29184
  v_mfma_f32_16x16x32_bf16 v[44:47], v[100:103], v[92:95], v[44:47]
  s_add_u32 m0, s44, 122880
  s_nop 0
  buffer_load_dwordx4 v10, s[4:7], s48 offen lds
  ds_read_b64_tr_b16 v[148:149], v17 offset:28672
  v_mfma_f32_16x16x32_bf16 v[48:51], v[104:107], v[88:91], v[48:51]
  ds_read_b64_tr_b16 v[150:151], v17 offset:29184
  ds_read_b64_tr_b16 v[152:153], v16 offset:36864
  v_mfma_f32_16x16x32_bf16 v[56:59], v[104:107], v[92:95], v[56:59]
  s_add_u32 m0, s44, 123904
  s_nop 0
  buffer_load_dwordx4 v11, s[4:7], s48 offen lds
  v_mfma_f32_16x16x32_bf16 v[52:55], v[108:111], v[88:91], v[52:55]
  ds_read_b64_tr_b16 v[154:155], v16 offset:37376
  ds_read_b64_tr_b16 v[156:157], v17 offset:36864
  v_mfma_f32_16x16x32_bf16 v[60:63], v[108:111], v[92:95], v[60:63]
  ds_read_b64_tr_b16 v[158:159], v17 offset:37376
  s_waitcnt vmcnt(18) lgkmcnt(0)
  s_barrier
  v_mfma_f32_16x16x32_bf16 v[32:35], v[120:123], v[112:115], v[32:35]
  ds_read_b128 v[64:67], v18 offset:0
  s_add_u32 s53, s52, 12
  s_and_b32 s53, s53, 15
  s_lshl_b32 s48, s53, 7
  s_mul_i32 s49, s53, 458752
  s_add_u32 m0, s44, 8192
  s_nop 0
  buffer_load_dwordx4 v12, s[8:11], s49 offen lds
  v_mfma_f32_16x16x32_bf16 v[40:43], v[120:123], v[116:119], v[40:43]
  ds_read_b128 v[68:71], v18 offset:2048
  ds_read_b64_tr_b16 v[72:73], v20 offset:0
  v_mfma_f32_16x16x32_bf16 v[36:39], v[124:127], v[112:115], v[36:39]
  ds_read_b64_tr_b16 v[74:75], v20 offset:512
  v_mfma_f32_16x16x32_bf16 v[44:47], v[124:127], v[116:119], v[44:47]
  s_add_u32 m0, s44, 9216
  s_nop 0
  buffer_load_dwordx4 v13, s[8:11], s49 offen lds
  ds_read_b64_tr_b16 v[76:77], v21 offset:0
  v_mfma_f32_16x16x32_bf16 v[48:51], v[128:131], v[112:115], v[48:51]
  ds_read_b64_tr_b16 v[78:79], v21 offset:512
  ds_read_b64_tr_b16 v[80:81], v20 offset:8192
  v_mfma_f32_16x16x32_bf16 v[56:59], v[128:131], v[116:119], v[56:59]
  s_add_u32 m0, s44, 16384
  s_nop 0
  buffer_load_dwordx4 v12, s[12:15], s49 offen lds
  v_mfma_f32_16x16x32_bf16 v[52:55], v[132:135], v[112:115], v[52:55]
  ds_read_b64_tr_b16 v[82:83], v20 offset:8704
  ds_read_b64_tr_b16 v[84:85], v21 offset:8192
  v_mfma_f32_16x16x32_bf16 v[60:63], v[132:135], v[116:119], v[60:63]
  ds_read_b64_tr_b16 v[86:87], v21 offset:8704
  v_mfma_f32_16x16x32_bf16 v[32:35], v[144:147], v[136:139], v[32:35]
  ds_read_b128 v[88:91], v19 offset:0
  s_add_u32 m0, s44, 17408
  s_nop 0
  buffer_load_dwordx4 v13, s[12:15], s49 offen lds
  v_mfma_f32_16x16x32_bf16 v[40:43], v[144:147], v[140:143], v[40:43]
  ds_read_b128 v[92:95], v19 offset:2048
  ds_read_b64_tr_b16 v[96:97], v20 offset:4096
  v_mfma_f32_16x16x32_bf16 v[36:39], v[148:151], v[136:139], v[36:39]
  ds_read_b64_tr_b16 v[98:99], v20 offset:4608
  v_mfma_f32_16x16x32_bf16 v[44:47], v[148:151], v[140:143], v[44:47]
  s_add_u32 m0, s44, 0
  s_nop 0
  buffer_load_dwordx4 v10, s[4:7], s48 offen lds
  ds_read_b64_tr_b16 v[100:101], v21 offset:4096
  v_mfma_f32_16x16x32_bf16 v[48:51], v[152:155], v[136:139], v[48:51]
  ds_read_b64_tr_b16 v[102:103], v21 offset:4608
  ds_read_b64_tr_b16 v[104:105], v20 offset:12288
  v_mfma_f32_16x16x32_bf16 v[56:59], v[152:155], v[140:143], v[56:59]
  s_add_u32 m0, s44, 1024
  s_nop 0
  buffer_load_dwordx4 v11, s[4:7], s48 offen lds
  v_mfma_f32_16x16x32_bf16 v[52:55], v[156:159], v[136:139], v[52:55]
  ds_read_b64_tr_b16 v[106:107], v20 offset:12800
  ds_read_b64_tr_b16 v[108:109], v21 offset:12288
  v_mfma_f32_16x16x32_bf16 v[60:63], v[156:159], v[140:143], v[60:63]
  ds_read_b64_tr_b16 v[110:111], v21 offset:12800
  s_waitcnt vmcnt(18) lgkmcnt(0)
  s_barrier
  v_mfma_f32_16x16x32_bf16 v[32:35], v[72:75], v[64:67], v[32:35]
  ds_read_b128 v[112:115], v18 offset:24576
  s_add_u32 s53, s52, 13
  s_and_b32 s53, s53, 15
  s_lshl_b32 s48, s53, 7
  s_mul_i32 s49, s53, 458752
  s_add_u32 m0, s44, 32768
  s_nop 0
  buffer_load_dwordx4 v12, s[8:11], s49 offen lds
  v_mfma_f32_16x16x32_bf16 v[40:43], v[72:75], v[68:71], v[40:43]
  ds_read_b128 v[116:119], v18 offset:26624
  ds_read_b64_tr_b16 v[120:121], v20 offset:24576
  v_mfma_f32_16x16x32_bf16 v[36:39], v[76:79], v[64:67], v[36:39]
  ds_read_b64_tr_b16 v[122:123], v20 offset:25088
  v_mfma_f32_16x16x32_bf16 v[44:47], v[76:79], v[68:71], v[44:47]
  s_add_u32 m0, s44, 33792
  s_nop 0
  buffer_load_dwordx4 v13, s[8:11], s49 offen lds
  ds_read_b64_tr_b16 v[124:125], v21 offset:24576
  v_mfma_f32_16x16x32_bf16 v[48:51], v[80:83], v[64:67], v[48:51]
  ds_read_b64_tr_b16 v[126:127], v21 offset:25088
  ds_read_b64_tr_b16 v[128:129], v20 offset:32768
  v_mfma_f32_16x16x32_bf16 v[56:59], v[80:83], v[68:71], v[56:59]
  s_add_u32 m0, s44, 40960
  s_nop 0
  buffer_load_dwordx4 v12, s[12:15], s49 offen lds
  v_mfma_f32_16x16x32_bf16 v[52:55], v[84:87], v[64:67], v[52:55]
  ds_read_b64_tr_b16 v[130:131], v20 offset:33280
  ds_read_b64_tr_b16 v[132:133], v21 offset:32768
  v_mfma_f32_16x16x32_bf16 v[60:63], v[84:87], v[68:71], v[60:63]
  ds_read_b64_tr_b16 v[134:135], v21 offset:33280
  v_mfma_f32_16x16x32_bf16 v[32:35], v[96:99], v[88:91], v[32:35]
  ds_read_b128 v[136:139], v19 offset:24576
  s_add_u32 m0, s44, 41984
  s_nop 0
  buffer_load_dwordx4 v13, s[12:15], s49 offen lds
  v_mfma_f32_16x16x32_bf16 v[40:43], v[96:99], v[92:95], v[40:43]
  ds_read_b128 v[140:143], v19 offset:26624
  ds_read_b64_tr_b16 v[144:145], v20 offset:28672
  v_mfma_f32_16x16x32_bf16 v[36:39], v[100:103], v[88:91], v[36:39]
  ds_read_b64_tr_b16 v[146:147], v20 offset:29184
  v_mfma_f32_16x16x32_bf16 v[44:47], v[100:103], v[92:95], v[44:47]
  s_add_u32 m0, s44, 24576
  s_nop 0
  buffer_load_dwordx4 v10, s[4:7], s48 offen lds
  ds_read_b64_tr_b16 v[148:149], v21 offset:28672
  v_mfma_f32_16x16x32_bf16 v[48:51], v[104:107], v[88:91], v[48:51]
  ds_read_b64_tr_b16 v[150:151], v21 offset:29184
  ds_read_b64_tr_b16 v[152:153], v20 offset:36864
  v_mfma_f32_16x16x32_bf16 v[56:59], v[104:107], v[92:95], v[56:59]
  s_add_u32 m0, s44, 25600
  s_nop 0
  buffer_load_dwordx4 v11, s[4:7], s48 offen lds
  v_mfma_f32_16x16x32_bf16 v[52:55], v[108:111], v[88:91], v[52:55]
  ds_read_b64_tr_b16 v[154:155], v20 offset:37376
  ds_read_b64_tr_b16 v[156:157], v21 offset:36864
  v_mfma_f32_16x16x32_bf16 v[60:63], v[108:111], v[92:95], v[60:63]
  ds_read_b64_tr_b16 v[158:159], v21 offset:37376
  s_waitcnt vmcnt(18) lgkmcnt(0)
  s_barrier
  v_mfma_f32_16x16x32_bf16 v[32:35], v[120:123], v[112:115], v[32:35]
  ds_read_b128 v[64:67], v22 offset:0
  s_add_u32 s53, s52, 14
  s_and_b32 s53, s53, 15
  s_lshl_b32 s48, s53, 7
  s_mul_i32 s49, s53, 458752
  s_add_u32 m0, s44, 57344
  s_nop 0
  buffer_load_dwordx4 v12, s[8:11], s49 offen lds
  v_mfma_f32_16x16x32_bf16 v[40:43], v[120:123], v[116:119], v[40:43]
  ds_read_b128 v[68:71], v22 offset:2048
  ds_read_b64_tr_b16 v[72:73], v24 offset:0
  v_mfma_f32_16x16x32_bf16 v[36:39], v[124:127], v[112:115], v[36:39]
  ds_read_b64_tr_b16 v[74:75], v24 offset:512
  v_mfma_f32_16x16x32_bf16 v[44:47], v[124:127], v[116:119], v[44:47]
  s_add_u32 m0, s44, 58368
  s_nop 0
  buffer_load_dwordx4 v13, s[8:11], s49 offen lds
  ds_read_b64_tr_b16 v[76:77], v25 offset:0
  v_mfma_f32_16x16x32_bf16 v[48:51], v[128:131], v[112:115], v[48:51]
  ds_read_b64_tr_b16 v[78:79], v25 offset:512
  ds_read_b64_tr_b16 v[80:81], v24 offset:8192
  v_mfma_f32_16x16x32_bf16 v[56:59], v[128:131], v[116:119], v[56:59]
  s_add_u32 m0, s44, 65536
  s_nop 0
  buffer_load_dwordx4 v12, s[12:15], s49 offen lds
  v_mfma_f32_16x16x32_bf16 v[52:55], v[132:135], v[112:115], v[52:55]
  ds_read_b64_tr_b16 v[82:83], v24 offset:8704
  ds_read_b64_tr_b16 v[84:85], v25 offset:8192
  v_mfma_f32_16x16x32_bf16 v[60:63], v[132:135], v[116:119], v[60:63]
  ds_read_b64_tr_b16 v[86:87], v25 offset:8704
  v_mfma_f32_16x16x32_bf16 v[32:35], v[144:147], v[136:139], v[32:35]
  ds_read_b128 v[88:91], v23 offset:0
  s_add_u32 m0, s44, 66560
  s_nop 0
  buffer_load_dwordx4 v13, s[12:15], s49 offen lds
  v_mfma_f32_16x16x32_bf16 v[40:43], v[144:147], v[140:143], v[40:43]
  ds_read_b128 v[92:95], v23 offset:2048
  ds_read_b64_tr_b16 v[96:97], v24 offset:4096
  v_mfma_f32_16x16x32_bf16 v[36:39], v[148:151], v[136:139], v[36:39]
  ds_read_b64_tr_b16 v[98:99], v24 offset:4608
  v_mfma_f32_16x16x32_bf16 v[44:47], v[148:151], v[140:143], v[44:47]
  s_add_u32 m0, s44, 49152
  s_nop 0
  buffer_load_dwordx4 v10, s[4:7], s48 offen lds
  ds_read_b64_tr_b16 v[100:101], v25 offset:4096
  v_mfma_f32_16x16x32_bf16 v[48:51], v[152:155], v[136:139], v[48:51]
  ds_read_b64_tr_b16 v[102:103], v25 offset:4608
  ds_read_b64_tr_b16 v[104:105], v24 offset:12288
  v_mfma_f32_16x16x32_bf16 v[56:59], v[152:155], v[140:143], v[56:59]
  s_add_u32 m0, s44, 50176
  s_nop 0
  buffer_load_dwordx4 v11, s[4:7], s48 offen lds
  v_mfma_f32_16x16x32_bf16 v[52:55], v[156:159], v[136:139], v[52:55]
  ds_read_b64_tr_b16 v[106:107], v24 offset:12800
  ds_read_b64_tr_b16 v[108:109], v25 offset:12288
  v_mfma_f32_16x16x32_bf16 v[60:63], v[156:159], v[140:143], v[60:63]
  ds_read_b64_tr_b16 v[110:111], v25 offset:12800
  s_waitcnt vmcnt(18) lgkmcnt(0)
  s_barrier
  v_mfma_f32_16x16x32_bf16 v[32:35], v[72:75], v[64:67], v[32:35]
  ds_read_b128 v[112:115], v22 offset:24576
  s_add_u32 s53, s52, 15
  s_and_b32 s53, s53, 15
  s_lshl_b32 s48, s53, 7
  s_mul_i32 s49, s53, 458752
  s_add_u32 m0, s44, 81920
  s_nop 0
  buffer_load_dwordx4 v12, s[8:11], s49 offen lds
  v_mfma_f32_16x16x32_bf16 v[40:43], v[72:75], v[68:71], v[40:43]
  ds_read_b128 v[116:119], v22 offset:26624
  ds_read_b64_tr_b16 v[120:121], v24 offset:24576
  v_mfma_f32_16x16x32_bf16 v[36:39], v[76:79], v[64:67], v[36:39]
  ds_read_b64_tr_b16 v[122:123], v24 offset:25088
  v_mfma_f32_16x16x32_bf16 v[44:47], v[76:79], v[68:71], v[44:47]
  s_add_u32 m0, s44, 82944
  s_nop 0
  buffer_load_dwordx4 v13, s[8:11], s49 offen lds
  ds_read_b64_tr_b16 v[124:125], v25 offset:24576
  v_mfma_f32_16x16x32_bf16 v[48:51], v[80:83], v[64:67], v[48:51]
  ds_read_b64_tr_b16 v[126:127], v25 offset:25088
  ds_read_b64_tr_b16 v[128:129], v24 offset:32768
  v_mfma_f32_16x16x32_bf16 v[56:59], v[80:83], v[68:71], v[56:59]
  s_add_u32 m0, s44, 90112
  s_nop 0
  buffer_load_dwordx4 v12, s[12:15], s49 offen lds
  v_mfma_f32_16x16x32_bf16 v[52:55], v[84:87], v[64:67], v[52:55]
  ds_read_b64_tr_b16 v[130:131], v24 offset:33280
  ds_read_b64_tr_b16 v[132:133], v25 offset:32768
  v_mfma_f32_16x16x32_bf16 v[60:63], v[84:87], v[68:71], v[60:63]
  ds_read_b64_tr_b16 v[134:135], v25 offset:33280
  v_mfma_f32_16x16x32_bf16 v[32:35], v[96:99], v[88:91], v[32:35]
  ds_read_b128 v[136:139], v23 offset:24576
  s_add_u32 m0, s44, 91136
  s_nop 0
  buffer_load_dwordx4 v13, s[12:15], s49 offen lds
  v_mfma_f32_16x16x32_bf16 v[40:43], v[96:99], v[92:95], v[40:43]
  ds_read_b128 v[140:143], v23 offset:26624
  ds_read_b64_tr_b16 v[144:145], v24 offset:28672
  v_mfma_f32_16x16x32_bf16 v[36:39], v[100:103], v[88:91], v[36:39]
  ds_read_b64_tr_b16 v[146:147], v24 offset:29184
  v_mfma_f32_16x16x32_bf16 v[44:47], v[100:103], v[92:95], v[44:47]
  s_add_u32 m0, s44, 73728
  s_nop 0
  buffer_load_dwordx4 v10, s[4:7], s48 offen lds
  ds_read_b64_tr_b16 v[148:149], v25 offset:28672
  v_mfma_f32_16x16x32_bf16 v[48:51], v[104:107], v[88:91], v[48:51]
  ds_read_b64_tr_b16 v[150:151], v25 offset:29184
  ds_read_b64_tr_b16 v[152:153], v24 offset:36864
  v_mfma_f32_16x16x32_bf16 v[56:59], v[104:107], v[92:95], v[56:59]
  s_add_u32 m0, s44, 74752
  s_nop 0
  buffer_load_dwordx4 v11, s[4:7], s48 offen lds
  v_mfma_f32_16x16x32_bf16 v[52:55], v[108:111], v[88:91], v[52:55]
  ds_read_b64_tr_b16 v[154:155], v24 offset:37376
  ds_read_b64_tr_b16 v[156:157], v25 offset:36864
  v_mfma_f32_16x16x32_bf16 v[60:63], v[108:111], v[92:95], v[60:63]
  ds_read_b64_tr_b16 v[158:159], v25 offset:37376
  s_waitcnt vmcnt(18) lgkmcnt(0)
  s_barrier
  v_mfma_f32_16x16x32_bf16 v[32:35], v[120:123], v[112:115], v[32:35]
  ds_read_b128 v[64:67], v14 offset:0
  ds_read_b128 v[68:71], v14 offset:2048
  v_mfma_f32_16x16x32_bf16 v[40:43], v[120:123], v[116:119], v[40:43]
  ds_read_b64_tr_b16 v[72:73], v16 offset:0
  v_mfma_f32_16x16x32_bf16 v[36:39], v[124:127], v[112:115], v[36:39]
  ds_read_b64_tr_b16 v[74:75], v16 offset:512
  v_mfma_f32_16x16x32_bf16 v[44:47], v[124:127], v[116:119], v[44:47]
  ds_read_b64_tr_b16 v[76:77], v17 offset:0
  v_mfma_f32_16x16x32_bf16 v[48:51], v[128:131], v[112:115], v[48:51]
  ds_read_b64_tr_b16 v[78:79], v17 offset:512
  ds_read_b64_tr_b16 v[80:81], v16 offset:8192
  v_mfma_f32_16x16x32_bf16 v[56:59], v[128:131], v[116:119], v[56:59]
  ds_read_b64_tr_b16 v[82:83], v16 offset:8704
  v_mfma_f32_16x16x32_bf16 v[52:55], v[132:135], v[112:115], v[52:55]
  ds_read_b64_tr_b16 v[84:85], v17 offset:8192
  v_mfma_f32_16x16x32_bf16 v[60:63], v[132:135], v[116:119], v[60:63]
  ds_read_b64_tr_b16 v[86:87], v17 offset:8704
  v_mfma_f32_16x16x32_bf16 v[32:35], v[144:147], v[136:139], v[32:35]
  ds_read_b128 v[88:91], v15 offset:0
  ds_read_b128 v[92:95], v15 offset:2048
  v_mfma_f32_16x16x32_bf16 v[40:43], v[144:147], v[140:143], v[40:43]
  ds_read_b64_tr_b16 v[96:97], v16 offset:4096
  v_mfma_f32_16x16x32_bf16 v[36:39], v[148:151], v[136:139], v[36:39]
  ds_read_b64_tr_b16 v[98:99], v16 offset:4608
  v_mfma_f32_16x16x32_bf16 v[44:47], v[148:151], v[140:143], v[44:47]
  ds_read_b64_tr_b16 v[100:101], v17 offset:4096
  v_mfma_f32_16x16x32_bf16 v[48:51], v[152:155], v[136:139], v[48:51]
  ds_read_b64_tr_b16 v[102:103], v17 offset:4608
  ds_read_b64_tr_b16 v[104:105], v16 offset:12288
  v_mfma_f32_16x16x32_bf16 v[56:59], v[152:155], v[140:143], v[56:59]
  ds_read_b64_tr_b16 v[106:107], v16 offset:12800
  v_mfma_f32_16x16x32_bf16 v[52:55], v[156:159], v[136:139], v[52:55]
  ds_read_b64_tr_b16 v[108:109], v17 offset:12288
  v_mfma_f32_16x16x32_bf16 v[60:63], v[156:159], v[140:143], v[60:63]
  ds_read_b64_tr_b16 v[110:111], v17 offset:12800
  s_waitcnt vmcnt(12) lgkmcnt(0)
  s_barrier
  v_mfma_f32_16x16x32_bf16 v[32:35], v[72:75], v[64:67], v[32:35]
  ds_read_b128 v[112:115], v14 offset:24576
  ds_read_b128 v[116:119], v14 offset:26624
  v_mfma_f32_16x16x32_bf16 v[40:43], v[72:75], v[68:71], v[40:43]
  ds_read_b64_tr_b16 v[120:121], v16 offset:24576
  v_mfma_f32_16x16x32_bf16 v[36:39], v[76:79], v[64:67], v[36:39]
  ds_read_b64_tr_b16 v[122:123], v16 offset:25088
  v_mfma_f32_16x16x32_bf16 v[44:47], v[76:79], v[68:71], v[44:47]
  ds_read_b64_tr_b16 v[124:125], v17 offset:24576
  v_mfma_f32_16x16x32_bf16 v[48:51], v[80:83], v[64:67], v[48:51]
  ds_read_b64_tr_b16 v[126:127], v17 offset:25088
  ds_read_b64_tr_b16 v[128:129], v16 offset:32768
  v_mfma_f32_16x16x32_bf16 v[56:59], v[80:83], v[68:71], v[56:59]
  ds_read_b64_tr_b16 v[130:131], v16 offset:33280
  v_mfma_f32_16x16x32_bf16 v[52:55], v[84:87], v[64:67], v[52:55]
  ds_read_b64_tr_b16 v[132:133], v17 offset:32768
  v_mfma_f32_16x16x32_bf16 v[60:63], v[84:87], v[68:71], v[60:63]
  ds_read_b64_tr_b16 v[134:135], v17 offset:33280
  v_mfma_f32_16x16x32_bf16 v[32:35], v[96:99], v[88:91], v[32:35]
  ds_read_b128 v[136:139], v15 offset:24576
  ds_read_b128 v[140:143], v15 offset:26624
  v_mfma_f32_16x16x32_bf16 v[40:43], v[96:99], v[92:95], v[40:43]
  ds_read_b64_tr_b16 v[144:145], v16 offset:28672
  v_mfma_f32_16x16x32_bf16 v[36:39], v[100:103], v[88:91], v[36:39]
  ds_read_b64_tr_b16 v[146:147], v16 offset:29184
  v_mfma_f32_16x16x32_bf16 v[44:47], v[100:103], v[92:95], v[44:47]
  ds_read_b64_tr_b16 v[148:149], v17 offset:28672
  v_mfma_f32_16x16x32_bf16 v[48:51], v[104:107], v[88:91], v[48:51]
  ds_read_b64_tr_b16 v[150:151], v17 offset:29184
  ds_read_b64_tr_b16 v[152:153], v16 offset:36864
  v_mfma_f32_16x16x32_bf16 v[56:59], v[104:107], v[92:95], v[56:59]
  ds_read_b64_tr_b16 v[154:155], v16 offset:37376
  v_mfma_f32_16x16x32_bf16 v[52:55], v[108:111], v[88:91], v[52:55]
  ds_read_b64_tr_b16 v[156:157], v17 offset:36864
  v_mfma_f32_16x16x32_bf16 v[60:63], v[108:111], v[92:95], v[60:63]
  ds_read_b64_tr_b16 v[158:159], v17 offset:37376
  s_waitcnt vmcnt(6) lgkmcnt(0)
  s_barrier
  v_mfma_f32_16x16x32_bf16 v[32:35], v[120:123], v[112:115], v[32:35]
  ds_read_b128 v[64:67], v18 offset:0
  ds_read_b128 v[68:71], v18 offset:2048
  v_mfma_f32_16x16x32_bf16 v[40:43], v[120:123], v[116:119], v[40:43]
  ds_read_b64_tr_b16 v[72:73], v20 offset:0
  v_mfma_f32_16x16x32_bf16 v[36:39], v[124:127], v[112:115], v[36:39]
  ds_read_b64_tr_b16 v[74:75], v20 offset:512
  v_mfma_f32_16x16x32_bf16 v[44:47], v[124:127], v[116:119], v[44:47]
  ds_read_b64_tr_b16 v[76:77], v21 offset:0
  v_mfma_f32_16x16x32_bf16 v[48:51], v[128:131], v[112:115], v[48:51]
  ds_read_b64_tr_b16 v[78:79], v21 offset:512
  ds_read_b64_tr_b16 v[80:81], v20 offset:8192
  v_mfma_f32_16x16x32_bf16 v[56:59], v[128:131], v[116:119], v[56:59]
  ds_read_b64_tr_b16 v[82:83], v20 offset:8704
  v_mfma_f32_16x16x32_bf16 v[52:55], v[132:135], v[112:115], v[52:55]
  ds_read_b64_tr_b16 v[84:85], v21 offset:8192
  v_mfma_f32_16x16x32_bf16 v[60:63], v[132:135], v[116:119], v[60:63]
  ds_read_b64_tr_b16 v[86:87], v21 offset:8704
  v_mfma_f32_16x16x32_bf16 v[32:35], v[144:147], v[136:139], v[32:35]
  ds_read_b128 v[88:91], v19 offset:0
  ds_read_b128 v[92:95], v19 offset:2048
  v_mfma_f32_16x16x32_bf16 v[40:43], v[144:147], v[140:143], v[40:43]
  ds_read_b64_tr_b16 v[96:97], v20 offset:4096
  v_mfma_f32_16x16x32_bf16 v[36:39], v[148:151], v[136:139], v[36:39]
  ds_read_b64_tr_b16 v[98:99], v20 offset:4608
  v_mfma_f32_16x16x32_bf16 v[44:47], v[148:151], v[140:143], v[44:47]
  ds_read_b64_tr_b16 v[100:101], v21 offset:4096
  v_mfma_f32_16x16x32_bf16 v[48:51], v[152:155], v[136:139], v[48:51]
  ds_read_b64_tr_b16 v[102:103], v21 offset:4608
  ds_read_b64_tr_b16 v[104:105], v20 offset:12288
  v_mfma_f32_16x16x32_bf16 v[56:59], v[152:155], v[140:143], v[56:59]
  ds_read_b64_tr_b16 v[106:107], v20 offset:12800
  v_mfma_f32_16x16x32_bf16 v[52:55], v[156:159], v[136:139], v[52:55]
  ds_read_b64_tr_b16 v[108:109], v21 offset:12288
  v_mfma_f32_16x16x32_bf16 v[60:63], v[156:159], v[140:143], v[60:63]
  ds_read_b64_tr_b16 v[110:111], v21 offset:12800
  s_waitcnt vmcnt(0) lgkmcnt(0)
  s_barrier
  v_mfma_f32_16x16x32_bf16 v[32:35], v[72:75], v[64:67], v[32:35]
  ds_read_b128 v[112:115], v18 offset:24576
  ds_read_b128 v[116:119], v18 offset:26624
  v_mfma_f32_16x16x32_bf16 v[40:43], v[72:75], v[68:71], v[40:43]
  ds_read_b64_tr_b16 v[120:121], v20 offset:24576
  v_mfma_f32_16x16x32_bf16 v[36:39], v[76:79], v[64:67], v[36:39]
  ds_read_b64_tr_b16 v[122:123], v20 offset:25088
  v_mfma_f32_16x16x32_bf16 v[44:47], v[76:79], v[68:71], v[44:47]
  ds_read_b64_tr_b16 v[124:125], v21 offset:24576
  v_mfma_f32_16x16x32_bf16 v[48:51], v[80:83], v[64:67], v[48:51]
  ds_read_b64_tr_b16 v[126:127], v21 offset:25088
  ds_read_b64_tr_b16 v[128:129], v20 offset:32768
  v_mfma_f32_16x16x32_bf16 v[56:59], v[80:83], v[68:71], v[56:59]
  ds_read_b64_tr_b16 v[130:131], v20 offset:33280
  v_mfma_f32_16x16x32_bf16 v[52:55], v[84:87], v[64:67], v[52:55]
  ds_read_b64_tr_b16 v[132:133], v21 offset:32768
  v_mfma_f32_16x16x32_bf16 v[60:63], v[84:87], v[68:71], v[60:63]
  ds_read_b64_tr_b16 v[134:135], v21 offset:33280
  v_mfma_f32_16x16x32_bf16 v[32:35], v[96:99], v[88:91], v[32:35]
  ds_read_b128 v[136:139], v19 offset:24576
  ds_read_b128 v[140:143], v19 offset:26624
  v_mfma_f32_16x16x32_bf16 v[40:43], v[96:99], v[92:95], v[40:43]
  ds_read_b64_tr_b16 v[144:145], v20 offset:28672
  v_mfma_f32_16x16x32_bf16 v[36:39], v[100:103], v[88:91], v[36:39]
  ds_read_b64_tr_b16 v[146:147], v20 offset:29184
  v_mfma_f32_16x16x32_bf16 v[44:47], v[100:103], v[92:95], v[44:47]
  ds_read_b64_tr_b16 v[148:149], v21 offset:28672
  v_mfma_f32_16x16x32_bf16 v[48:51], v[104:107], v[88:91], v[48:51]
  ds_read_b64_tr_b16 v[150:151], v21 offset:29184
  ds_read_b64_tr_b16 v[152:153], v20 offset:36864
  v_mfma_f32_16x16x32_bf16 v[56:59], v[104:107], v[92:95], v[56:59]
  ds_read_b64_tr_b16 v[154:155], v20 offset:37376
  v_mfma_f32_16x16x32_bf16 v[52:55], v[108:111], v[88:91], v[52:55]
  ds_read_b64_tr_b16 v[156:157], v21 offset:36864
  v_mfma_f32_16x16x32_bf16 v[60:63], v[108:111], v[92:95], v[60:63]
  ds_read_b64_tr_b16 v[158:159], v21 offset:37376
  s_waitcnt lgkmcnt(0)
  v_mfma_f32_16x16x32_bf16 v[32:35], v[120:123], v[112:115], v[32:35]
  v_mfma_f32_16x16x32_bf16 v[40:43], v[120:123], v[116:119], v[40:43]
  v_mfma_f32_16x16x32_bf16 v[36:39], v[124:127], v[112:115], v[36:39]
  v_mfma_f32_16x16x32_bf16 v[44:47], v[124:127], v[116:119], v[44:47]
  v_mfma_f32_16x16x32_bf16 v[48:51], v[128:131], v[112:115], v[48:51]
  v_mfma_f32_16x16x32_bf16 v[56:59], v[128:131], v[116:119], v[56:59]
  v_mfma_f32_16x16x32_bf16 v[52:55], v[132:135], v[112:115], v[52:55]
  v_mfma_f32_16x16x32_bf16 v[60:63], v[132:135], v[116:119], v[60:63]
  v_mfma_f32_16x16x32_bf16 v[32:35], v[144:147], v[136:139], v[32:35]
  v_mfma_f32_16x16x32_bf16 v[40:43], v[144:147], v[140:143], v[40:43]
  v_mfma_f32_16x16x32_bf16 v[36:39], v[148:151], v[136:139], v[36:39]
  v_mfma_f32_16x16x32_bf16 v[44:47], v[148:151], v[140:143], v[44:47]
  v_mfma_f32_16x16x32_bf16 v[48:51], v[152:155], v[136:139], v[48:51]
  v_mfma_f32_16x16x32_bf16 v[56:59], v[152:155], v[140:143], v[56:59]
  v_mfma_f32_16x16x32_bf16 v[52:55], v[156:159], v[136:139], v[52:55]
  v_mfma_f32_16x16x32_bf16 v[60:63], v[156:159], v[140:143], v[60:63]
  v_and_b32 v5, 15, v1
  s_lshl_b32 s47, s45, 5
  s_add_u32 s47, s47, s37
  v_add_u32 v5, s47, v5
  v_mul_lo_u32 v5, v5, s42
  v_lshrrev_b32 v6, 4, v1
  v_lshlrev_b32 v6, 3, v6
  s_lshl_b32 s47, s46, 6
  s_add_u32 s47, s47, s43
  v_add_u32 v6, s47, v6
  v_add_u32 v26, v5, v6
  v_add_u32 v27, 114688, v26
  s_mov_b32 s50, 0xbfb8aa3b
  s_mov_b32 s51, 0xffff0000
  s_nop 7
  v_cvt_pk_bf16_f32 v76, v32, v33
  v_cvt_pk_bf16_f32 v77, v34, v35
  v_cvt_pk_bf16_f32 v78, v48, v49
  v_cvt_pk_bf16_f32 v79, v50, v51
  v_lshlrev_b32 v64, 16, v76
  v_and_b32 v65, s51, v76
  v_lshlrev_b32 v68, 16, v78
  v_and_b32 v69, s51, v78
  v_lshlrev_b32 v66, 16, v77
  v_and_b32 v67, s51, v77
  v_lshlrev_b32 v70, 16, v79
  v_and_b32 v71, s51, v79
  v_mul_f32 v72, s50, v64
  v_mul_f32 v73, s50, v65
  v_mul_f32 v74, s50, v66
  v_mul_f32 v75, s50, v67
  v_exp_f32 v72, v72
  v_exp_f32 v73, v73
  v_exp_f32 v74, v74
  v_exp_f32 v75, v75
  v_add_f32 v72, 1.0, v72
  v_add_f32 v73, 1.0, v73
  v_add_f32 v74, 1.0, v74
  v_add_f32 v75, 1.0, v75
  v_rcp_f32 v72, v72
  v_rcp_f32 v73, v73
  v_rcp_f32 v74, v74
  v_rcp_f32 v75, v75
  v_mul_f32 v72, v64, v72
  v_mul_f32 v73, v65, v73
  v_mul_f32 v74, v66, v74
  v_mul_f32 v75, v67, v75
  v_cvt_pk_bf16_f32 v76, v72, v73
  v_cvt_pk_bf16_f32 v77, v74, v75
  v_lshlrev_b32 v72, 16, v76
  v_and_b32 v73, s51, v76
  v_lshlrev_b32 v74, 16, v77
  v_and_b32 v75, s51, v77
  v_mul_f32 v72, v72, v68
  v_mul_f32 v73, v73, v69
  v_mul_f32 v74, v74, v70
  v_mul_f32 v75, v75, v71
  v_cvt_pk_bf16_f32 v80, v72, v73
  v_cvt_pk_bf16_f32 v81, v74, v75
  buffer_store_dwordx2 v[80:81], v26, s[16:19], 0 offen offset:0
  v_cvt_pk_bf16_f32 v100, v36, v37
  v_cvt_pk_bf16_f32 v101, v38, v39
  v_cvt_pk_bf16_f32 v102, v52, v53
  v_cvt_pk_bf16_f32 v103, v54, v55
  v_lshlrev_b32 v88, 16, v100
  v_and_b32 v89, s51, v100
  v_lshlrev_b32 v92, 16, v102
  v_and_b32 v93, s51, v102
  v_lshlrev_b32 v90, 16, v101
  v_and_b32 v91, s51, v101
  v_lshlrev_b32 v94, 16, v103
  v_and_b32 v95, s51, v103
  v_mul_f32 v96, s50, v88
  v_mul_f32 v97, s50, v89
  v_mul_f32 v98, s50, v90
  v_mul_f32 v99, s50, v91
  v_exp_f32 v96, v96
  v_exp_f32 v97, v97
  v_exp_f32 v98, v98
  v_exp_f32 v99, v99
  v_add_f32 v96, 1.0, v96
  v_add_f32 v97, 1.0, v97
  v_add_f32 v98, 1.0, v98
  v_add_f32 v99, 1.0, v99
  v_rcp_f32 v96, v96
  v_rcp_f32 v97, v97
  v_rcp_f32 v98, v98
  v_rcp_f32 v99, v99
  v_mul_f32 v96, v88, v96
  v_mul_f32 v97, v89, v97
  v_mul_f32 v98, v90, v98
  v_mul_f32 v99, v91, v99
  v_cvt_pk_bf16_f32 v100, v96, v97
  v_cvt_pk_bf16_f32 v101, v98, v99
  v_lshlrev_b32 v96, 16, v100
  v_and_b32 v97, s51, v100
  v_lshlrev_b32 v98, 16, v101
  v_and_b32 v99, s51, v101
  v_mul_f32 v96, v96, v92
  v_mul_f32 v97, v97, v93
  v_mul_f32 v98, v98, v94
  v_mul_f32 v99, v99, v95
  v_cvt_pk_bf16_f32 v104, v96, v97
  v_cvt_pk_bf16_f32 v105, v98, v99
  buffer_store_dwordx2 v[104:105], v26, s[16:19], 0 offen offset:32
  v_cvt_pk_bf16_f32 v124, v40, v41
  v_cvt_pk_bf16_f32 v125, v42, v43
  v_cvt_pk_bf16_f32 v126, v56, v57
  v_cvt_pk_bf16_f32 v127, v58, v59
  v_lshlrev_b32 v112, 16, v124
  v_and_b32 v113, s51, v124
  v_lshlrev_b32 v116, 16, v126
  v_and_b32 v117, s51, v126
  v_lshlrev_b32 v114, 16, v125
  v_and_b32 v115, s51, v125
  v_lshlrev_b32 v118, 16, v127
  v_and_b32 v119, s51, v127
  v_mul_f32 v120, s50, v112
  v_mul_f32 v121, s50, v113
  v_mul_f32 v122, s50, v114
  v_mul_f32 v123, s50, v115
  v_exp_f32 v120, v120
  v_exp_f32 v121, v121
  v_exp_f32 v122, v122
  v_exp_f32 v123, v123
  v_add_f32 v120, 1.0, v120
  v_add_f32 v121, 1.0, v121
  v_add_f32 v122, 1.0, v122
  v_add_f32 v123, 1.0, v123
  v_rcp_f32 v120, v120
  v_rcp_f32 v121, v121
  v_rcp_f32 v122, v122
  v_rcp_f32 v123, v123
  v_mul_f32 v120, v112, v120
  v_mul_f32 v121, v113, v121
  v_mul_f32 v122, v114, v122
  v_mul_f32 v123, v115, v123
  v_cvt_pk_bf16_f32 v124, v120, v121
  v_cvt_pk_bf16_f32 v125, v122, v123
  v_lshlrev_b32 v120, 16, v124
  v_and_b32 v121, s51, v124
  v_lshlrev_b32 v122, 16, v125
  v_and_b32 v123, s51, v125
  v_mul_f32 v120, v120, v116
  v_mul_f32 v121, v121, v117
  v_mul_f32 v122, v122, v118
  v_mul_f32 v123, v123, v119
  v_cvt_pk_bf16_f32 v128, v120, v121
  v_cvt_pk_bf16_f32 v129, v122, v123
  buffer_store_dwordx2 v[128:129], v27, s[16:19], 0 offen offset:0
  v_cvt_pk_bf16_f32 v148, v44, v45
  v_cvt_pk_bf16_f32 v149, v46, v47
  v_cvt_pk_bf16_f32 v150, v60, v61
  v_cvt_pk_bf16_f32 v151, v62, v63
  v_lshlrev_b32 v136, 16, v148
  v_and_b32 v137, s51, v148
  v_lshlrev_b32 v140, 16, v150
  v_and_b32 v141, s51, v150
  v_lshlrev_b32 v138, 16, v149
  v_and_b32 v139, s51, v149
  v_lshlrev_b32 v142, 16, v151
  v_and_b32 v143, s51, v151
  v_mul_f32 v144, s50, v136
  v_mul_f32 v145, s50, v137
  v_mul_f32 v146, s50, v138
  v_mul_f32 v147, s50, v139
  v_exp_f32 v144, v144
  v_exp_f32 v145, v145
  v_exp_f32 v146, v146
  v_exp_f32 v147, v147
  v_add_f32 v144, 1.0, v144
  v_add_f32 v145, 1.0, v145
  v_add_f32 v146, 1.0, v146
  v_add_f32 v147, 1.0, v147
  v_rcp_f32 v144, v144
  v_rcp_f32 v145, v145
  v_rcp_f32 v146, v146
  v_rcp_f32 v147, v147
  v_mul_f32 v144, v136, v144
  v_mul_f32 v145, v137, v145
  v_mul_f32 v146, v138, v146
  v_mul_f32 v147, v139, v147
  v_cvt_pk_bf16_f32 v148, v144, v145
  v_cvt_pk_bf16_f32 v149, v146, v147
  v_lshlrev_b32 v144, 16, v148
  v_and_b32 v145, s51, v148
  v_lshlrev_b32 v146, 16, v149
  v_and_b32 v147, s51, v149
  v_mul_f32 v144, v144, v140
  v_mul_f32 v145, v145, v141
  v_mul_f32 v146, v146, v142
  v_mul_f32 v147, v147, v143
  v_cvt_pk_bf16_f32 v152, v144, v145
  v_cvt_pk_bf16_f32 v153, v146, v147
  buffer_store_dwordx2 v[152:153], v27, s[16:19], 0 offen offset:32
L_k1_end:
  s_endpgm
.globl ffn_down_kernel
.p2align 8
.type ffn_down_kernel,@function
ffn_down_kernel:
  s_cmp_ge_u32 s2, 256
  s_cbranch_scc1 L_k2_end
  s_load_dwordx4 s[24:27], s[0:1], 24
  s_load_dwordx2 s[28:29], s[0:1], 48
  s_and_b32 s32, s2, 7
  s_lshr_b32 s33, s2, 3
  s_lshr_b32 s34, s33, 1
  s_and_b32 s35, s33, 1
  s_lshl_b32 s36, s32, 1
  s_add_u32 s36, s36, s35
  s_lshl_b32 s37, s34, 4
  s_lshl_b32 s38, s36, 6
  v_and_b32 v1, 63, v0
  v_lshrrev_b32 v2, 6, v0
  v_lshrrev_b32 v3, 3, v1
  v_readfirstlane_b32 s39, v2
  v_and_b32 v4, 7, v1
  s_mul_i32 s40, s39, 896
  s_mul_i32 s52, s35, 7
  s_mul_i32 s53, s34, 1
  s_add_u32 s52, s52, s53
  s_mul_hi_u32 s53, s52, 0x12492493
  s_mul_i32 s53, s53, 14
  s_sub_u32 s52, s52, s53
  v_add_u32 v5, s37, v3
  s_movk_i32 s42, 7168
  v_mul_lo_u32 v5, v5, s42
  s_lshl_b32 s41, s40, 1
  v_add_u32 v5, s41, v5
  v_xor_b32 v6, v4, v3
  v_lshlrev_b32 v6, 4, v6
  v_add_u32 v10, v5, v6
  v_add_u32 v5, s40, v3
  v_lshlrev_b32 v5, 11, v5
  s_lshl_b32 s43, s38, 1
  v_add_u32 v5, s43, v5
  v_and_b32 v6, 3, v3
  v_xor_b32 v7, v4, v6
  v_lshlrev_b32 v7, 4, v7
  v_add_u32 v11, v5, v7
  v_xor_b32 v7, 4, v6
  v_xor_b32 v7, v4, v7
  v_lshlrev_b32 v7, 4, v7
  v_add_u32 v12, v5, v7
  s_mul_i32 s44, s39, 40960
  s_waitcnt lgkmcnt(0)
  s_mov_b32 s4, s28
  s_and_b32 s5, s29, 0xffff
  s_mov_b32 s6, 1835008
  s_mov_b32 s7, 0x00020000
  s_mov_b32 s8, s24
  s_and_b32 s9, s25, 0xffff
  s_mov_b32 s10, 7340032
  s_mov_b32 s11, 0x00020000
  s_add_u32 s53, s52, 0
  s_cmp_ge_u32 s53, 28
  s_cselect_b32 s54, 28, 0
  s_sub_u32 s53, s53, s54
  s_cmp_ge_u32 s53, 14
  s_cselect_b32 s54, 14, 0
  s_sub_u32 s53, s53, s54
  s_lshl_b32 s54, s53, 7
  s_lshl_b32 s55, s53, 17
  s_add_u32 s48, s54, 0
  s_add_u32 m0, s44, 0
  s_nop 0
  buffer_load_dwordx4 v10, s[4:7], s48 offen lds
  s_add_u32 s48, s54, 57344
  s_add_u32 m0, s44, 1024
  s_nop 0
  buffer_load_dwordx4 v10, s[4:7], s48 offen lds
  s_add_u32 s48, s55, 0
  s_add_u32 m0, s44, 2048
  s_nop 0
  buffer_load_dwordx4 v11, s[8:11], s48 offen lds
  s_add_u32 s48, s55, 16384
  s_add_u32 m0, s44, 3072
  s_nop 0
  buffer_load_dwordx4 v12, s[8:11], s48 offen lds
  s_add_u32 s48, s55, 32768
  s_add_u32 m0, s44, 4096
  s_nop 0
  buffer_load_dwordx4 v11, s[8:11], s48 offen lds
  s_add_u32 s48, s55, 49152
  s_add_u32 m0, s44, 5120
  s_nop 0
  buffer_load_dwordx4 v12, s[8:11], s48 offen lds
  s_add_u32 s48, s55, 65536
  s_add_u32 m0, s44, 6144
  s_nop 0
  buffer_load_dwordx4 v11, s[8:11], s48 offen lds
  s_add_u32 s48, s55, 81920
  s_add_u32 m0, s44, 7168
  s_nop 0
  buffer_load_dwordx4 v12, s[8:11], s48 offen lds
  s_add_u32 s48, s55, 98304
  s_add_u32 m0, s44, 8192
  s_nop 0
  buffer_load_dwordx4 v11, s[8:11], s48 offen lds
  s_add_u32 s48, s55, 114688
  s_add_u32 m0, s44, 9216
  s_nop 0
  buffer_load_dwordx4 v12, s[8:11], s48 offen lds
  s_mov_b32 s16, s26
  s_and_b32 s17, s27, 0xffff
  s_mov_b32 s18, 524288
  s_mov_b32 s19, 0x00020000
  v_and_b32 v5, 15, v1
  v_lshlrev_b32 v5, 7, v5
  v_add_u32 v5, s44, v5
  v_lshrrev_b32 v6, 4, v1
  v_xor_b32 v7, v6, v4
  v_lshlrev_b32 v8, 4, v7
  v_add_u32 v14, v5, v8
  v_xor_b32 v7, 4, v7
  v_lshlrev_b32 v8, 4, v7
  v_add_u32 v15, v5, v8
  v_lshrrev_b32 v7, 2, v1
  v_and_b32 v7, 3, v7
  v_lshlrev_b32 v8, 3, v6
  v_add_u32 v8, v8, v7
  v_lshlrev_b32 v8, 7, v8
  v_and_b32 v9, 1, v1
  v_lshlrev_b32 v9, 3, v9
  v_add_u32 v8, v8, v9
  v_add_u32 v8, 2048, v8
  v_add_u32 v8, s44, v8
  v_and_b32 v9, 1, v6
  v_lshlrev_b32 v9, 2, v9
  v_or_b32 v9, v9, v7
  v_lshrrev_b32 v5, 1, v1
  v_and_b32 v5, 1, v5
  v_xor_b32 v7, v5, v9
  v_lshlrev_b32 v7, 4, v7
  v_add_u32 v16, v8, v7
  v_add_u32 v5, 2, v5
  v_xor_b32 v7, v5, v9
  v_lshlrev_b32 v7, 4, v7
  v_add_u32 v17, v8, v7
  v_add_u32 v5, 2, v5
  v_xor_b32 v7, v5, v9
  v_lshlrev_b32 v7, 4, v7
  v_add_u32 v18, v8, v7
  v_add_u32 v5, 2, v5
  v_xor_b32 v7, v5, v9
  v_lshlrev_b32 v7, 4, v7
  v_add_u32 v19, v8, v7
  v_mov_b32 v32, 0
  v_mov_b32 v33, 0
  v_mov_b32 v34, 0
  v_mov_b32 v35, 0
  v_mov_b32 v36, 0
  v_mov_b32 v37, 0
  v_mov_b32 v38, 0
  v_mov_b32 v39, 0
  v_mov_b32 v40, 0
  v_mov_b32 v41, 0
  v_mov_b32 v42, 0
  v_mov_b32 v43, 0
  v_mov_b32 v44, 0
  v_mov_b32 v45, 0
  v_mov_b32 v46, 0
  v_mov_b32 v47, 0
  s_add_u32 s53, s52, 1
  s_cmp_ge_u32 s53, 28
  s_cselect_b32 s54, 28, 0
  s_sub_u32 s53, s53, s54
  s_cmp_ge_u32 s53, 14
  s_cselect_b32 s54, 14, 0
  s_sub_u32 s53, s53, s54
  s_lshl_b32 s54, s53, 7
  s_lshl_b32 s55, s53, 17
  s_add_u32 s48, s54, 0
  s_add_u32 m0, s44, 10240
  s_nop 0
  buffer_load_dwordx4 v10, s[4:7], s48 offen lds
  s_add_u32 s48, s54, 57344
  s_add_u32 m0, s44, 11264
  s_nop 0
  buffer_load_dwordx4 v10, s[4:7], s48 offen lds
  s_add_u32 s48, s55, 0
  s_add_u32 m0, s44, 12288
  s_nop 0
  buffer_load_dwordx4 v11, s[8:11], s48 offen lds
  s_add_u32 s48, s55, 16384
  s_add_u32 m0, s44, 13312
  s_nop 0
  buffer_load_dwordx4 v12, s[8:11], s48 offen lds
  s_add_u32 s48, s55, 32768
  s_add_u32 m0, s44, 14336
  s_nop 0
  buffer_load_dwordx4 v11, s[8:11], s48 offen lds
  s_add_u32 s48, s55, 49152
  s_add_u32 m0, s44, 15360
  s_nop 0
  buffer_load_dwordx4 v12, s[8:11], s48 offen lds
  s_add_u32 s48, s55, 65536
  s_add_u32 m0, s44, 16384
  s_nop 0
  buffer_load_dwordx4 v11, s[8:11], s48 offen lds
  s_add_u32 s48, s55, 81920
  s_add_u32 m0, s44, 17408
  s_nop 0
  buffer_load_dwordx4 v12, s[8:11], s48 offen lds
  s_add_u32 s48, s55, 98304
  s_add_u32 m0, s44, 18432
  s_nop 0
  buffer_load_dwordx4 v11, s[8:11], s48 offen lds
  s_add_u32 s48, s55, 114688
  s_add_u32 m0, s44, 19456
  s_nop 0
  buffer_load_dwordx4 v12, s[8:11], s48 offen lds
  s_add_u32 s53, s52, 2
  s_cmp_ge_u32 s53, 28
  s_cselect_b32 s54, 28, 0
  s_sub_u32 s53, s53, s54
  s_cmp_ge_u32 s53, 14
  s_cselect_b32 s54, 14, 0
  s_sub_u32 s53, s53, s54
  s_lshl_b32 s54, s53, 7
  s_lshl_b32 s55, s53, 17
  s_add_u32 s48, s54, 0
  s_add_u32 m0, s44, 20480
  s_nop 0
  buffer_load_dwordx4 v10, s[4:7], s48 offen lds
  s_add_u32 s48, s54, 57344
  s_add_u32 m0, s44, 21504
  s_nop 0
  buffer_load_dwordx4 v10, s[4:7], s48 offen lds
  s_add_u32 s48, s55, 0
  s_add_u32 m0, s44, 22528
  s_nop 0
  buffer_load_dwordx4 v11, s[8:11], s48 offen lds
  s_add_u32 s48, s55, 16384
  s_add_u32 m0, s44, 23552
  s_nop 0
  buffer_load_dwordx4 v12, s[8:11], s48 offen lds
  s_add_u32 s48, s55, 32768
  s_add_u32 m0, s44, 24576
  s_nop 0
  buffer_load_dwordx4 v11, s[8:11], s48 offen lds
  s_add_u32 s48, s55, 49152
  s_add_u32 m0, s44, 25600
  s_nop 0
  buffer_load_dwordx4 v12, s[8:11], s48 offen lds
  s_add_u32 s48, s55, 65536
  s_add_u32 m0, s44, 26624
  s_nop 0
  buffer_load_dwordx4 v11, s[8:11], s48 offen lds
  s_add_u32 s48, s55, 81920
  s_add_u32 m0, s44, 27648
  s_nop 0
  buffer_load_dwordx4 v12, s[8:11], s48 offen lds
  s_add_u32 s48, s55, 98304
  s_add_u32 m0, s44, 28672
  s_nop 0
  buffer_load_dwordx4 v11, s[8:11], s48 offen lds
  s_add_u32 s48, s55, 114688
  s_add_u32 m0, s44, 29696
  s_nop 0
  buffer_load_dwordx4 v12, s[8:11], s48 offen lds
  s_waitcnt vmcnt(20)
  ds_read_b128 v[64:67], v14 offset:0
  ds_read_b64_tr_b16 v[68:69], v16 offset:0
  ds_read_b64_tr_b16 v[70:71], v16 offset:512
  ds_read_b64_tr_b16 v[72:73], v17 offset:0
  ds_read_b64_tr_b16 v[74:75], v17 offset:512
  ds_read_b64_tr_b16 v[76:77], v18 offset:0
  ds_read_b64_tr_b16 v[78:79], v18 offset:512
  ds_read_b64_tr_b16 v[80:81], v19 offset:0
  ds_read_b64_tr_b16 v[82:83], v19 offset:512
  ds_read_b128 v[84:87], v15 offset:0
  ds_read_b64_tr_b16 v[88:89], v16 offset:4096
  ds_read_b64_tr_b16 v[90:91], v16 offset:4608
  ds_read_b64_tr_b16 v[92:93], v17 offset:4096
  ds_read_b64_tr_b16 v[94:95], v17 offset:4608
  ds_read_b64_tr_b16 v[96:97], v18 offset:4096
  ds_read_b64_tr_b16 v[98:99], v18 offset:4608
  ds_read_b64_tr_b16 v[100:101], v19 offset:4096
  ds_read_b64_tr_b16 v[102:103], v19 offset:4608
  s_waitcnt vmcnt(10) lgkmcnt(0)
  v_mfma_f32_16x16x32_bf16 v[32:35], v[68:71], v[64:67], v[32:35]
  ds_read_b128 v[104:107], v14 offset:10240
  s_add_u32 s53, s52, 3
  s_cmp_ge_u32 s53, 28
  s_cselect_b32 s54, 28, 0
  s_sub_u32 s53, s53, s54
  s_cmp_ge_u32 s53, 14
  s_cselect_b32 s54, 14, 0
  s_sub_u32 s53, s53, s54
  s_lshl_b32 s54, s53, 7
  s_lshl_b32 s55, s53, 17
  s_add_u32 s48, s54, 0
  s_add_u32 m0, s44, 30720
  s_nop 0
  buffer_load_dwordx4 v10, s[4:7], s48 offen lds
  s_add_u32 s48, s54, 57344
  s_add_u32 m0, s44, 31744
  s_nop 0
  buffer_load_dwordx4 v10, s[4:7], s48 offen lds
  ds_read_b64_tr_b16 v[108:109], v16 offset:10240
  s_add_u32 s48, s55, 0
  s_add_u32 m0, s44, 32768
  s_nop 0
  buffer_load_dwordx4 v11, s[8:11], s48 offen lds
  v_mfma_f32_16x16x32_bf16 v[36:39], v[72:75], v[64:67], v[36:39]
  ds_read_b64_tr_b16 v[110:111], v16 offset:10752
  s_add_u32 s48, s55, 16384
  s_add_u32 m0, s44, 33792
  s_nop 0
  buffer_load_dwordx4 v12, s[8:11], s48 offen lds
  ds_read_b64_tr_b16 v[112:113], v17 offset:10240
  s_add_u32 s48, s55, 32768
  s_add_u32 m0, s44, 34816
  s_nop 0
  buffer_load_dwordx4 v11, s[8:11], s48 offen lds
  ds_read_b64_tr_b16 v[114:115], v17 offset:10752
  v_mfma_f32_16x16x32_bf16 v[40:43], v[76:79], v[64:67], v[40:43]
  s_add_u32 s48, s55, 49152
  s_add_u32 m0, s44, 35840
  s_nop 0
  buffer_load_dwordx4 v12, s[8:11], s48 offen lds
  ds_read_b64_tr_b16 v[116:117], v18 offset:10240
  s_add_u32 s48, s55, 65536
  s_add_u32 m0, s44, 36864
  s_nop 0
  buffer_load_dwordx4 v11, s[8:11], s48 offen lds
  ds_read_b64_tr_b16 v[118:119], v18 offset:10752
  s_add_u32 s48, s55, 81920
  s_add_u32 m0, s44, 37888
  s_nop 0
  buffer_load_dwordx4 v12, s[8:11], s48 offen lds
  v_mfma_f32_16x16x32_bf16 v[44:47], v[80:83], v[64:67], v[44:47]
  ds_read_b64_tr_b16 v[120:121], v19 offset:10240
  s_add_u32 s48, s55, 98304
  s_add_u32 m0, s44, 38912
  s_nop 0
  buffer_load_dwordx4 v11, s[8:11], s48 offen lds
  ds_read_b64_tr_b16 v[122:123], v19 offset:10752
  s_add_u32 s48, s55, 114688
  s_add_u32 m0, s44, 39936
  s_nop 0
  buffer_load_dwordx4 v12, s[8:11], s48 offen lds
  v_mfma_f32_16x16x32_bf16 v[32:35], v[88:91], v[84:87], v[32:35]
  ds_read_b128 v[124:127], v15 offset:10240
  s_add_u32 s53, s52, 4
  s_cmp_ge_u32 s53, 28
  s_cselect_b32 s54, 28, 0
  s_sub_u32 s53, s53, s54
  s_cmp_ge_u32 s53, 14
  s_cselect_b32 s54, 14, 0
  s_sub_u32 s53, s53, s54
  s_lshl_b32 s54, s53, 7
  s_lshl_b32 s55, s53, 17
  s_add_u32 s48, s54, 0
  s_add_u32 m0, s44, 0
  s_nop 0
  buffer_load_dwordx4 v10, s[4:7], s48 offen lds
  s_add_u32 s48, s54, 57344
  s_add_u32 m0, s44, 1024
  s_nop 0
  buffer_load_dwordx4 v10, s[4:7], s48 offen lds
  ds_read_b64_tr_b16 v[128:129], v16 offset:14336
  s_add_u32 s48, s55, 0
  s_add_u32 m0, s44, 2048
  s_nop 0
  buffer_load_dwordx4 v11, s[8:11], s48 offen lds
  v_mfma_f32_16x16x32_bf16 v[36:39], v[92:95], v[84:87], v[36:39]
  ds_read_b64_tr_b16 v[130:131], v16 offset:14848
  s_add_u32 s48, s55, 16384
  s_add_u32 m0, s44, 3072
  s_nop 0
  buffer_load_dwordx4 v12, s[8:11], s48 offen lds
  ds_read_b64_tr_b16 v[132:133], v17 offset:14336
  s_add_u32 s48, s55, 32768
  s_add_u32 m0, s44, 4096
  s_nop 0
  buffer_load_dwordx4 v11, s[8:11], s48 offen lds
  ds_read_b64_tr_b16 v[134:135], v17 offset:14848
  v_mfma_f32_16x16x32_bf16 v[40:43], v[96:99], v[84:87], v[40:43]
  s_add_u32 s48, s55, 49152
  s_add_u32 m0, s44, 5120
  s_nop 0
  buffer_load_dwordx4 v12, s[8:11], s48 offen lds
  ds_read_b64_tr_b16 v[136:137], v18 offset:14336
  s_add_u32 s48, s55, 65536
  s_add_u32 m0, s44, 6144
  s_nop 0
  buffer_load_dwordx4 v11, s[8:11], s48 offen lds
  ds_read_b64_tr_b16 v[138:139], v18 offset:14848
  s_add_u32 s48, s55, 81920
  s_add_u32 m0, s44, 7168
  s_nop 0
  buffer_load_dwordx4 v12, s[8:11], s48 offen lds
  v_mfma_f32_16x16x32_bf16 v[44:47], v[100:103], v[84:87], v[44:47]
  ds_read_b64_tr_b16 v[140:141], v19 offset:14336
  s_add_u32 s48, s55, 98304
  s_add_u32 m0, s44, 8192
  s_nop 0
  buffer_load_dwordx4 v11, s[8:11], s48 offen lds
  ds_read_b64_tr_b16 v[142:143], v19 offset:14848
  s_add_u32 s48, s55, 114688
  s_add_u32 m0, s44, 9216
  s_nop 0
  buffer_load_dwordx4 v12, s[8:11], s48 offen lds
  s_waitcnt vmcnt(20) lgkmcnt(0)
  v_mfma_f32_16x16x32_bf16 v[32:35], v[108:111], v[104:107], v[32:35]
  ds_read_b128 v[64:67], v14 offset:20480
  s_add_u32 s53, s52, 5
  s_cmp_ge_u32 s53, 28
  s_cselect_b32 s54, 28, 0
  s_sub_u32 s53, s53, s54
  s_cmp_ge_u32 s53, 14
  s_cselect_b32 s54, 14, 0
  s_sub_u32 s53, s53, s54
  s_lshl_b32 s54, s53, 7
  s_lshl_b32 s55, s53, 17
  s_add_u32 s48, s54, 0
  s_add_u32 m0, s44, 10240
  s_nop 0
  buffer_load_dwordx4 v10, s[4:7], s48 offen lds
  ds_read_b64_tr_b16 v[68:69], v16 offset:20480
  s_add_u32 s48, s54, 57344
  s_add_u32 m0, s44, 11264
  s_nop 0
  buffer_load_dwordx4 v10, s[4:7], s48 offen lds
  v_mfma_f32_16x16x32_bf16 v[36:39], v[112:115], v[104:107], v[36:39]
  ds_read_b64_tr_b16 v[70:71], v16 offset:20992
  ds_read_b64_tr_b16 v[72:73], v17 offset:20480
  s_add_u32 s48, s55, 0
  s_add_u32 m0, s44, 12288
  s_nop 0
  buffer_load_dwordx4 v11, s[8:11], s48 offen lds
  v_mfma_f32_16x16x32_bf16 v[40:43], v[116:119], v[104:107], v[40:43]
  ds_read_b64_tr_b16 v[74:75], v17 offset:20992
  ds_read_b64_tr_b16 v[76:77], v18 offset:20480
  s_add_u32 s48, s55, 16384
  s_add_u32 m0, s44, 13312
  s_nop 0
  buffer_load_dwordx4 v12, s[8:11], s48 offen lds
  ds_read_b64_tr_b16 v[78:79], v18 offset:20992
  v_mfma_f32_16x16x32_bf16 v[44:47], v[120:123], v[104:107], v[44:47]
  ds_read_b64_tr_b16 v[80:81], v19 offset:20480
  s_add_u32 s48, s55, 32768
  s_add_u32 m0, s44, 14336
  s_nop 0
  buffer_load_dwordx4 v11, s[8:11], s48 offen lds
  ds_read_b64_tr_b16 v[82:83], v19 offset:20992
  v_mfma_f32_16x16x32_bf16 v[32:35], v[128:131], v[124:127], v[32:35]
  ds_read_b128 v[84:87], v15 offset:20480
  s_add_u32 s48, s55, 49152
  s_add_u32 m0, s44, 15360
  s_nop 0
  buffer_load_dwordx4 v12, s[8:11], s48 offen lds
  ds_read_b64_tr_b16 v[88:89], v16 offset:24576
  s_add_u32 s48, s55, 65536
  s_add_u32 m0, s44, 16384
  s_nop 0
  buffer_load_dwordx4 v11, s[8:11], s48 offen lds
  v_mfma_f32_16x16x32_bf16 v[36:39], v[132:135], v[124:127], v[36:39]
  ds_read_b64_tr_b16 v[90:91], v16 offset:25088
  ds_read_b64_tr_b16 v[92:93], v17 offset:24576
  s_add_u32 s48, s55, 81920
  s_add_u32 m0, s44, 17408
  s_nop 0
  buffer_load_dwordx4 v12, s[8:11], s48 offen lds
  v_mfma_f32_16x16x32_bf16 v[40:43], v[136:139], v[124:127], v[40:43]
  ds_read_b64_tr_b16 v[94:95], v17 offset:25088
  ds_read_b64_tr_b16 v[96:97], v18 offset:24576
  s_add_u32 s48, s55, 98304
  s_add_u32 m0, s44, 18432
  s_nop 0
  buffer_load_dwordx4 v11, s[8:11], s48 offen lds
  ds_read_b64_tr_b16 v[98:99], v18 offset:25088
  v_mfma_f32_16x16x32_bf16 v[44:47], v[140:143], v[124:127], v[44:47]
  ds_read_b64_tr_b16 v[100:101], v19 offset:24576
  s_add_u32 s48, s55, 114688
  s_add_u32 m0, s44, 19456
  s_nop 0
  buffer_load_dwordx4 v12, s[8:11], s48 offen lds
  ds_read_b64_tr_b16 v[102:103], v19 offset:25088
  s_waitcnt vmcnt(20) lgkmcnt(0)
  v_mfma_f32_16x16x32_bf16 v[32:35], v[68:71], v[64:67], v[32:35]
  ds_read_b128 v[104:107], v14 offset:30720
  s_add_u32 s53, s52, 6
  s_cmp_ge_u32 s53, 28
  s_cselect_b32 s54, 28, 0
  s_sub_u32 s53, s53, s54
  s_cmp_ge_u32 s53, 14
  s_cselect_b32 s54, 14, 0
  s_sub_u32 s53, s53, s54
  s_lshl_b32 s54, s53, 7
  s_lshl_b32 s55, s53, 17
  s_add_u32 s48, s54, 0
  s_add_u32 m0, s44, 20480
  s_nop 0
  buffer_load_dwordx4 v10, s[4:7], s48 offen lds
  ds_read_b64_tr_b16 v[108:109], v16 offset:30720
  s_add_u32 s48, s54, 57344
  s_add_u32 m0, s44, 21504
  s_nop 0
  buffer_load_dwordx4 v10, s[4:7], s48 offen lds
  v_mfma_f32_16x16x32_bf16 v[36:39], v[72:75], v[64:67], v[36:39]
  ds_read_b64_tr_b16 v[110:111], v16 offset:31232
  ds_read_b64_tr_b16 v[112:113], v17 offset:30720
  s_add_u32 s48, s55, 0
  s_add_u32 m0, s44, 22528
  s_nop 0
  buffer_load_dwordx4 v11, s[8:11], s48 offen lds
  v_mfma_f32_16x16x32_bf16 v[40:43], v[76:79], v[64:67], v[40:43]
  ds_read_b64_tr_b16 v[114:115], v17 offset:31232
  ds_read_b64_tr_b16 v[116:117], v18 offset:30720
  s_add_u32 s48, s55, 16384
  s_add_u32 m0, s44, 23552
  s_nop 0
  buffer_load_dwordx4 v12, s[8:11], s48 offen lds
  ds_read_b64_tr_b16 v[118:119], v18 offset:31232
  v_mfma_f32_16x16x32_bf16 v[44:47], v[80:83], v[64:67], v[44:47]
  ds_read_b64_tr_b16 v[120:121], v19 offset:30720
  s_add_u32 s48, s55, 32768
  s_add_u32 m0, s44, 24576
  s_nop 0
  buffer_load_dwordx4 v11, s[8:11], s48 offen lds
  ds_read_b64_tr_b16 v[122:123], v19 offset:31232
  v_mfma_f32_16x16x32_bf16 v[32:35], v[88:91], v[84:87], v[32:35]
  ds_read_b128 v[124:127], v15 offset:30720
  s_add_u32 s48, s55, 49152
  s_add_u32 m0, s44, 25600
  s_nop 0
  buffer_load_dwordx4 v12, s[8:11], s48 offen lds
  ds_read_b64_tr_b16 v[128:129], v16 offset:34816
  s_add_u32 s48, s55, 65536
  s_add_u32 m0, s44, 26624
  s_nop 0
  buffer_load_dwordx4 v11, s[8:11], s48 offen lds
  v_mfma_f32_16x16x32_bf16 v[36:39], v[92:95], v[84:87], v[36:39]
  ds_read_b64_tr_b16 v[130:131], v16 offset:35328
  ds_read_b64_tr_b16 v[132:133], v17 offset:34816
  s_add_u32 s48, s55, 81920
  s_add_u32 m0, s44, 27648
  s_nop 0
  buffer_load_dwordx4 v12, s[8:11], s48 offen lds
  v_mfma_f32_16x16x32_bf16 v[40:43], v[96:99], v[84:87], v[40:43]
  ds_read_b64_tr_b16 v[134:135], v17 offset:35328
  ds_read_b64_tr_b16 v[136:137], v18 offset:34816
  s_add_u32 s48, s55, 98304
  s_add_u32 m0, s44, 28672
  s_nop 0
  buffer_load_dwordx4 v11, s[8:11], s48 offen lds
  ds_read_b64_tr_b16 v[138:139], v18 offset:35328
  v_mfma_f32_16x16x32_bf16 v[44:47], v[100:103], v[84:87], v[44:47]
  ds_read_b64_tr_b16 v[140:141], v19 offset:34816
  s_add_u32 s48, s55, 114688
  s_add_u32 m0, s44, 29696
  s_nop 0
  buffer_load_dwordx4 v12, s[8:11], s48 offen lds
  ds_read_b64_tr_b16 v[142:143], v19 offset:35328
  s_waitcnt vmcnt(20) lgkmcnt(0)
  v_mfma_f32_16x16x32_bf16 v[32:35], v[108:111], v[104:107], v[32:35]
  ds_read_b128 v[64:67], v14 offset:0
  s_add_u32 s53, s52, 7
  s_cmp_ge_u32 s53, 28
  s_cselect_b32 s54, 28, 0
  s_sub_u32 s53, s53, s54
  s_cmp_ge_u32 s53, 14
  s_cselect_b32 s54, 14, 0
  s_sub_u32 s53, s53, s54
  s_lshl_b32 s54, s53, 7
  s_lshl_b32 s55, s53, 17
  s_add_u32 s48, s54, 0
  s_add_u32 m0, s44, 30720
  s_nop 0
  buffer_load_dwordx4 v10, s[4:7], s48 offen lds
  ds_read_b64_tr_b16 v[68:69], v16 offset:0
  s_add_u32 s48, s54, 57344
  s_add_u32 m0, s44, 31744
  s_nop 0
  buffer_load_dwordx4 v10, s[4:7], s48 offen lds
  v_mfma_f32_16x16x32_bf16 v[36:39], v[112:115], v[104:107], v[36:39]
  ds_read_b64_tr_b16 v[70:71], v16 offset:512
  ds_read_b64_tr_b16 v[72:73], v17 offset:0
  s_add_u32 s48, s55, 0
  s_add_u32 m0, s44, 32768
  s_nop 0
  buffer_load_dwordx4 v11, s[8:11], s48 offen lds
  v_mfma_f32_16x16x32_bf16 v[40:43], v[116:119], v[104:107], v[40:43]
  ds_read_b64_tr_b16 v[74:75], v17 offset:512
  ds_read_b64_tr_b16 v[76:77], v18 offset:0
  s_add_u32 s48, s55, 16384
  s_add_u32 m0, s44, 33792
  s_nop 0
  buffer_load_dwordx4 v12, s[8:11], s48 offen lds
  ds_read_b64_tr_b16 v[78:79], v18 offset:512
  v_mfma_f32_16x16x32_bf16 v[44:47], v[120:123], v[104:107], v[44:47]
  ds_read_b64_tr_b16 v[80:81], v19 offset:0
  s_add_u32 s48, s55, 32768
  s_add_u32 m0, s44, 34816
  s_nop 0
  buffer_load_dwordx4 v11, s[8:11], s48 offen lds
  ds_read_b64_tr_b16 v[82:83], v19 offset:512
  v_mfma_f32_16x16x32_bf16 v[32:35], v[128:131], v[124:127], v[32:35]
  ds_read_b128 v[84:87], v15 offset:0
  s_add_u32 s48, s55, 49152
  s_add_u32 m0, s44, 35840
  s_nop 0
  buffer_load_dwordx4 v12, s[8:11], s48 offen lds
  ds_read_b64_tr_b16 v[88:89], v16 offset:4096
  s_add_u32 s48, s55, 65536
  s_add_u32 m0, s44, 36864
  s_nop 0
  buffer_load_dwordx4 v11, s[8:11], s48 offen lds
  v_mfma_f32_16x16x32_bf16 v[36:39], v[132:135], v[124:127], v[36:39]
  ds_read_b64_tr_b16 v[90:91], v16 offset:4608
  ds_read_b64_tr_b16 v[92:93], v17 offset:4096
  s_add_u32 s48, s55, 81920
  s_add_u32 m0, s44, 37888
  s_nop 0
  buffer_load_dwordx4 v12, s[8:11], s48 offen lds
  v_mfma_f32_16x16x32_bf16 v[40:43], v[136:139], v[124:127], v[40:43]
  ds_read_b64_tr_b16 v[94:95], v17 offset:4608
  ds_read_b64_tr_b16 v[96:97], v18 offset:4096
  s_add_u32 s48, s55, 98304
  s_add_u32 m0, s44, 38912
  s_nop 0
  buffer_load_dwordx4 v11, s[8:11], s48 offen lds
  ds_read_b64_tr_b16 v[98:99], v18 offset:4608
  v_mfma_f32_16x16x32_bf16 v[44:47], v[140:143], v[124:127], v[44:47]
  ds_read_b64_tr_b16 v[100:101], v19 offset:4096
  s_add_u32 s48, s55, 114688
  s_add_u32 m0, s44, 39936
  s_nop 0
  buffer_load_dwordx4 v12, s[8:11], s48 offen lds
  ds_read_b64_tr_b16 v[102:103], v19 offset:4608
  s_waitcnt vmcnt(20) lgkmcnt(0)
  v_mfma_f32_16x16x32_bf16 v[32:35], v[68:71], v[64:67], v[32:35]
  ds_read_b128 v[104:107], v14 offset:10240
  s_add_u32 s53, s52, 8
  s_cmp_ge_u32 s53, 28
  s_cselect_b32 s54, 28, 0
  s_sub_u32 s53, s53, s54
  s_cmp_ge_u32 s53, 14
  s_cselect_b32 s54, 14, 0
  s_sub_u32 s53, s53, s54
  s_lshl_b32 s54, s53, 7
  s_lshl_b32 s55, s53, 17
  s_add_u32 s48, s54, 0
  s_add_u32 m0, s44, 0
  s_nop 0
  buffer_load_dwordx4 v10, s[4:7], s48 offen lds
  ds_read_b64_tr_b16 v[108:109], v16 offset:10240
  s_add_u32 s48, s54, 57344
  s_add_u32 m0, s44, 1024
  s_nop 0
  buffer_load_dwordx4 v10, s[4:7], s48 offen lds
  v_mfma_f32_16x16x32_bf16 v[36:39], v[72:75], v[64:67], v[36:39]
  ds_read_b64_tr_b16 v[110:111], v16 offset:10752
  ds_read_b64_tr_b16 v[112:113], v17 offset:10240
  s_add_u32 s48, s55, 0
  s_add_u32 m0, s44, 2048
  s_nop 0
  buffer_load_dwordx4 v11, s[8:11], s48 offen lds
  v_mfma_f32_16x16x32_bf16 v[40:43], v[76:79], v[64:67], v[40:43]
  ds_read_b64_tr_b16 v[114:115], v17 offset:10752
  ds_read_b64_tr_b16 v[116:117], v18 offset:10240
  s_add_u32 s48, s55, 16384
  s_add_u32 m0, s44, 3072
  s_nop 0
  buffer_load_dwordx4 v12, s[8:11], s48 offen lds
  ds_read_b64_tr_b16 v[118:119], v18 offset:10752
  v_mfma_f32_16x16x32_bf16 v[44:47], v[80:83], v[64:67], v[44:47]
  ds_read_b64_tr_b16 v[120:121], v19 offset:10240
  s_add_u32 s48, s55, 32768
  s_add_u32 m0, s44, 4096
  s_nop 0
  buffer_load_dwordx4 v11, s[8:11], s48 offen lds
  ds_read_b64_tr_b16 v[122:123], v19 offset:10752
  v_mfma_f32_16x16x32_bf16 v[32:35], v[88:91], v[84:87], v[32:35]
  ds_read_b128 v[124:127], v15 offset:10240
  s_add_u32 s48, s55, 49152
  s_add_u32 m0, s44, 5120
  s_nop 0
  buffer_load_dwordx4 v12, s[8:11], s48 offen lds
  ds_read_b64_tr_b16 v[128:129], v16 offset:14336
  s_add_u32 s48, s55, 65536
  s_add_u32 m0, s44, 6144
  s_nop 0
  buffer_load_dwordx4 v11, s[8:11], s48 offen lds
  v_mfma_f32_16x16x32_bf16 v[36:39], v[92:95], v[84:87], v[36:39]
  ds_read_b64_tr_b16 v[130:131], v16 offset:14848
  ds_read_b64_tr_b16 v[132:133], v17 offset:14336
  s_add_u32 s48, s55, 81920
  s_add_u32 m0, s44, 7168
  s_nop 0
  buffer_load_dwordx4 v12, s[8:11], s48 offen lds
  v_mfma_f32_16x16x32_bf16 v[40:43], v[96:99], v[84:87], v[40:43]
  ds_read_b64_tr_b16 v[134:135], v17 offset:14848
  ds_read_b64_tr_b16 v[136:137], v18 offset:14336
  s_add_u32 s48, s55, 98304
  s_add_u32 m0, s44, 8192
  s_nop 0
  buffer_load_dwordx4 v11, s[8:11], s48 offen lds
  ds_read_b64_tr_b16 v[138:139], v18 offset:14848
  v_mfma_f32_16x16x32_bf16 v[44:47], v[100:103], v[84:87], v[44:47]
  ds_read_b64_tr_b16 v[140:141], v19 offset:14336
  s_add_u32 s48, s55, 114688
  s_add_u32 m0, s44, 9216
  s_nop 0
  buffer_load_dwordx4 v12, s[8:11], s48 offen lds
  ds_read_b64_tr_b16 v[142:143], v19 offset:14848
  s_waitcnt vmcnt(20) lgkmcnt(0)
  v_mfma_f32_16x16x32_bf16 v[32:35], v[108:111], v[104:107], v[32:35]
  ds_read_b128 v[64:67], v14 offset:20480
  s_add_u32 s53, s52, 9
  s_cmp_ge_u32 s53, 28
  s_cselect_b32 s54, 28, 0
  s_sub_u32 s53, s53, s54
  s_cmp_ge_u32 s53, 14
  s_cselect_b32 s54, 14, 0
  s_sub_u32 s53, s53, s54
  s_lshl_b32 s54, s53, 7
  s_lshl_b32 s55, s53, 17
  s_add_u32 s48, s54, 0
  s_add_u32 m0, s44, 10240
  s_nop 0
  buffer_load_dwordx4 v10, s[4:7], s48 offen lds
  ds_read_b64_tr_b16 v[68:69], v16 offset:20480
  s_add_u32 s48, s54, 57344
  s_add_u32 m0, s44, 11264
  s_nop 0
  buffer_load_dwordx4 v10, s[4:7], s48 offen lds
  v_mfma_f32_16x16x32_bf16 v[36:39], v[112:115], v[104:107], v[36:39]
  ds_read_b64_tr_b16 v[70:71], v16 offset:20992
  ds_read_b64_tr_b16 v[72:73], v17 offset:20480
  s_add_u32 s48, s55, 0
  s_add_u32 m0, s44, 12288
  s_nop 0
  buffer_load_dwordx4 v11, s[8:11], s48 offen lds
  v_mfma_f32_16x16x32_bf16 v[40:43], v[116:119], v[104:107], v[40:43]
  ds_read_b64_tr_b16 v[74:75], v17 offset:20992
  ds_read_b64_tr_b16 v[76:77], v18 offset:20480
  s_add_u32 s48, s55, 16384
  s_add_u32 m0, s44, 13312
  s_nop 0
  buffer_load_dwordx4 v12, s[8:11], s48 offen lds
  ds_read_b64_tr_b16 v[78:79], v18 offset:20992
  v_mfma_f32_16x16x32_bf16 v[44:47], v[120:123], v[104:107], v[44:47]
  ds_read_b64_tr_b16 v[80:81], v19 offset:20480
  s_add_u32 s48, s55, 32768
  s_add_u32 m0, s44, 14336
  s_nop 0
  buffer_load_dwordx4 v11, s[8:11], s48 offen lds
  ds_read_b64_tr_b16 v[82:83], v19 offset:20992
  v_mfma_f32_16x16x32_bf16 v[32:35], v[128:131], v[124:127], v[32:35]
  ds_read_b128 v[84:87], v15 offset:20480
  s_add_u32 s48, s55, 49152
  s_add_u32 m0, s44, 15360
  s_nop 0
  buffer_load_dwordx4 v12, s[8:11], s48 offen lds
  ds_read_b64_tr_b16 v[88:89], v16 offset:24576
  s_add_u32 s48, s55, 65536
  s_add_u32 m0, s44, 16384
  s_nop 0
  buffer_load_dwordx4 v11, s[8:11], s48 offen lds
  v_mfma_f32_16x16x32_bf16 v[36:39], v[132:135], v[124:127], v[36:39]
  ds_read_b64_tr_b16 v[90:91], v16 offset:25088
  ds_read_b64_tr_b16 v[92:93], v17 offset:24576
  s_add_u32 s48, s55, 81920
  s_add_u32 m0, s44, 17408
  s_nop 0
  buffer_load_dwordx4 v12, s[8:11], s48 offen lds
  v_mfma_f32_16x16x32_bf16 v[40:43], v[136:139], v[124:127], v[40:43]
  ds_read_b64_tr_b16 v[94:95], v17 offset:25088
  ds_read_b64_tr_b16 v[96:97], v18 offset:24576
  s_add_u32 s48, s55, 98304
  s_add_u32 m0, s44, 18432
  s_nop 0
  buffer_load_dwordx4 v11, s[8:11], s48 offen lds
  ds_read_b64_tr_b16 v[98:99], v18 offset:25088
  v_mfma_f32_16x16x32_bf16 v[44:47], v[140:143], v[124:127], v[44:47]
  ds_read_b64_tr_b16 v[100:101], v19 offset:24576
  s_add_u32 s48, s55, 114688
  s_add_u32 m0, s44, 19456
  s_nop 0
  buffer_load_dwordx4 v12, s[8:11], s48 offen lds
  ds_read_b64_tr_b16 v[102:103], v19 offset:25088
  s_waitcnt vmcnt(20) lgkmcnt(0)
  v_mfma_f32_16x16x32_bf16 v[32:35], v[68:71], v[64:67], v[32:35]
  ds_read_b128 v[104:107], v14 offset:30720
  s_add_u32 s53, s52, 10
  s_cmp_ge_u32 s53, 28
  s_cselect_b32 s54, 28, 0
  s_sub_u32 s53, s53, s54
  s_cmp_ge_u32 s53, 14
  s_cselect_b32 s54, 14, 0
  s_sub_u32 s53, s53, s54
  s_lshl_b32 s54, s53, 7
  s_lshl_b32 s55, s53, 17
  s_add_u32 s48, s54, 0
  s_add_u32 m0, s44, 20480
  s_nop 0
  buffer_load_dwordx4 v10, s[4:7], s48 offen lds
  ds_read_b64_tr_b16 v[108:109], v16 offset:30720
  s_add_u32 s48, s54, 57344
  s_add_u32 m0, s44, 21504
  s_nop 0
  buffer_load_dwordx4 v10, s[4:7], s48 offen lds
  v_mfma_f32_16x16x32_bf16 v[36:39], v[72:75], v[64:67], v[36:39]
  ds_read_b64_tr_b16 v[110:111], v16 offset:31232
  ds_read_b64_tr_b16 v[112:113], v17 offset:30720
  s_add_u32 s48, s55, 0
  s_add_u32 m0, s44, 22528
  s_nop 0
  buffer_load_dwordx4 v11, s[8:11], s48 offen lds
  v_mfma_f32_16x16x32_bf16 v[40:43], v[76:79], v[64:67], v[40:43]
  ds_read_b64_tr_b16 v[114:115], v17 offset:31232
  ds_read_b64_tr_b16 v[116:117], v18 offset:30720
  s_add_u32 s48, s55, 16384
  s_add_u32 m0, s44, 23552
  s_nop 0
  buffer_load_dwordx4 v12, s[8:11], s48 offen lds
  ds_read_b64_tr_b16 v[118:119], v18 offset:31232
  v_mfma_f32_16x16x32_bf16 v[44:47], v[80:83], v[64:67], v[44:47]
  ds_read_b64_tr_b16 v[120:121], v19 offset:30720
  s_add_u32 s48, s55, 32768
  s_add_u32 m0, s44, 24576
  s_nop 0
  buffer_load_dwordx4 v11, s[8:11], s48 offen lds
  ds_read_b64_tr_b16 v[122:123], v19 offset:31232
  v_mfma_f32_16x16x32_bf16 v[32:35], v[88:91], v[84:87], v[32:35]
  ds_read_b128 v[124:127], v15 offset:30720
  s_add_u32 s48, s55, 49152
  s_add_u32 m0, s44, 25600
  s_nop 0
  buffer_load_dwordx4 v12, s[8:11], s48 offen lds
  ds_read_b64_tr_b16 v[128:129], v16 offset:34816
  s_add_u32 s48, s55, 65536
  s_add_u32 m0, s44, 26624
  s_nop 0
  buffer_load_dwordx4 v11, s[8:11], s48 offen lds
  v_mfma_f32_16x16x32_bf16 v[36:39], v[92:95], v[84:87], v[36:39]
  ds_read_b64_tr_b16 v[130:131], v16 offset:35328
  ds_read_b64_tr_b16 v[132:133], v17 offset:34816
  s_add_u32 s48, s55, 81920
  s_add_u32 m0, s44, 27648
  s_nop 0
  buffer_load_dwordx4 v12, s[8:11], s48 offen lds
  v_mfma_f32_16x16x32_bf16 v[40:43], v[96:99], v[84:87], v[40:43]
  ds_read_b64_tr_b16 v[134:135], v17 offset:35328
  ds_read_b64_tr_b16 v[136:137], v18 offset:34816
  s_add_u32 s48, s55, 98304
  s_add_u32 m0, s44, 28672
  s_nop 0
  buffer_load_dwordx4 v11, s[8:11], s48 offen lds
  ds_read_b64_tr_b16 v[138:139], v18 offset:35328
  v_mfma_f32_16x16x32_bf16 v[44:47], v[100:103], v[84:87], v[44:47]
  ds_read_b64_tr_b16 v[140:141], v19 offset:34816
  s_add_u32 s48, s55, 114688
  s_add_u32 m0, s44, 29696
  s_nop 0
  buffer_load_dwordx4 v12, s[8:11], s48 offen lds
  ds_read_b64_tr_b16 v[142:143], v19 offset:35328
  s_waitcnt vmcnt(20) lgkmcnt(0)
  v_mfma_f32_16x16x32_bf16 v[32:35], v[108:111], v[104:107], v[32:35]
  ds_read_b128 v[64:67], v14 offset:0
  s_add_u32 s53, s52, 11
  s_cmp_ge_u32 s53, 28
  s_cselect_b32 s54, 28, 0
  s_sub_u32 s53, s53, s54
  s_cmp_ge_u32 s53, 14
  s_cselect_b32 s54, 14, 0
  s_sub_u32 s53, s53, s54
  s_lshl_b32 s54, s53, 7
  s_lshl_b32 s55, s53, 17
  s_add_u32 s48, s54, 0
  s_add_u32 m0, s44, 30720
  s_nop 0
  buffer_load_dwordx4 v10, s[4:7], s48 offen lds
  ds_read_b64_tr_b16 v[68:69], v16 offset:0
  s_add_u32 s48, s54, 57344
  s_add_u32 m0, s44, 31744
  s_nop 0
  buffer_load_dwordx4 v10, s[4:7], s48 offen lds
  v_mfma_f32_16x16x32_bf16 v[36:39], v[112:115], v[104:107], v[36:39]
  ds_read_b64_tr_b16 v[70:71], v16 offset:512
  ds_read_b64_tr_b16 v[72:73], v17 offset:0
  s_add_u32 s48, s55, 0
  s_add_u32 m0, s44, 32768
  s_nop 0
  buffer_load_dwordx4 v11, s[8:11], s48 offen lds
  v_mfma_f32_16x16x32_bf16 v[40:43], v[116:119], v[104:107], v[40:43]
  ds_read_b64_tr_b16 v[74:75], v17 offset:512
  ds_read_b64_tr_b16 v[76:77], v18 offset:0
  s_add_u32 s48, s55, 16384
  s_add_u32 m0, s44, 33792
  s_nop 0
  buffer_load_dwordx4 v12, s[8:11], s48 offen lds
  ds_read_b64_tr_b16 v[78:79], v18 offset:512
  v_mfma_f32_16x16x32_bf16 v[44:47], v[120:123], v[104:107], v[44:47]
  ds_read_b64_tr_b16 v[80:81], v19 offset:0
  s_add_u32 s48, s55, 32768
  s_add_u32 m0, s44, 34816
  s_nop 0
  buffer_load_dwordx4 v11, s[8:11], s48 offen lds
  ds_read_b64_tr_b16 v[82:83], v19 offset:512
  v_mfma_f32_16x16x32_bf16 v[32:35], v[128:131], v[124:127], v[32:35]
  ds_read_b128 v[84:87], v15 offset:0
  s_add_u32 s48, s55, 49152
  s_add_u32 m0, s44, 35840
  s_nop 0
  buffer_load_dwordx4 v12, s[8:11], s48 offen lds
  ds_read_b64_tr_b16 v[88:89], v16 offset:4096
  s_add_u32 s48, s55, 65536
  s_add_u32 m0, s44, 36864
  s_nop 0
  buffer_load_dwordx4 v11, s[8:11], s48 offen lds
  v_mfma_f32_16x16x32_bf16 v[36:39], v[132:135], v[124:127], v[36:39]
  ds_read_b64_tr_b16 v[90:91], v16 offset:4608
  ds_read_b64_tr_b16 v[92:93], v17 offset:4096
  s_add_u32 s48, s55, 81920
  s_add_u32 m0, s44, 37888
  s_nop 0
  buffer_load_dwordx4 v12, s[8:11], s48 offen lds
  v_mfma_f32_16x16x32_bf16 v[40:43], v[136:139], v[124:127], v[40:43]
  ds_read_b64_tr_b16 v[94:95], v17 offset:4608
  ds_read_b64_tr_b16 v[96:97], v18 offset:4096
  s_add_u32 s48, s55, 98304
  s_add_u32 m0, s44, 38912
  s_nop 0
  buffer_load_dwordx4 v11, s[8:11], s48 offen lds
  ds_read_b64_tr_b16 v[98:99], v18 offset:4608
  v_mfma_f32_16x16x32_bf16 v[44:47], v[140:143], v[124:127], v[44:47]
  ds_read_b64_tr_b16 v[100:101], v19 offset:4096
  s_add_u32 s48, s55, 114688
  s_add_u32 m0, s44, 39936
  s_nop 0
  buffer_load_dwordx4 v12, s[8:11], s48 offen lds
  ds_read_b64_tr_b16 v[102:103], v19 offset:4608
  s_waitcnt vmcnt(20) lgkmcnt(0)
  v_mfma_f32_16x16x32_bf16 v[32:35], v[68:71], v[64:67], v[32:35]
  ds_read_b128 v[104:107], v14 offset:10240
  s_add_u32 s53, s52, 12
  s_cmp_ge_u32 s53, 28
  s_cselect_b32 s54, 28, 0
  s_sub_u32 s53, s53, s54
  s_cmp_ge_u32 s53, 14
  s_cselect_b32 s54, 14, 0
  s_sub_u32 s53, s53, s54
  s_lshl_b32 s54, s53, 7
  s_lshl_b32 s55, s53, 17
  s_add_u32 s48, s54, 0
  s_add_u32 m0, s44, 0
  s_nop 0
  buffer_load_dwordx4 v10, s[4:7], s48 offen lds
  ds_read_b64_tr_b16 v[108:109], v16 offset:10240
  s_add_u32 s48, s54, 57344
  s_add_u32 m0, s44, 1024
  s_nop 0
  buffer_load_dwordx4 v10, s[4:7], s48 offen lds
  v_mfma_f32_16x16x32_bf16 v[36:39], v[72:75], v[64:67], v[36:39]
  ds_read_b64_tr_b16 v[110:111], v16 offset:10752
  ds_read_b64_tr_b16 v[112:113], v17 offset:10240
  s_add_u32 s48, s55, 0
  s_add_u32 m0, s44, 2048
  s_nop 0
  buffer_load_dwordx4 v11, s[8:11], s48 offen lds
  v_mfma_f32_16x16x32_bf16 v[40:43], v[76:79], v[64:67], v[40:43]
  ds_read_b64_tr_b16 v[114:115], v17 offset:10752
  ds_read_b64_tr_b16 v[116:117], v18 offset:10240
  s_add_u32 s48, s55, 16384
  s_add_u32 m0, s44, 3072
  s_nop 0
  buffer_load_dwordx4 v12, s[8:11], s48 offen lds
  ds_read_b64_tr_b16 v[118:119], v18 offset:10752
  v_mfma_f32_16x16x32_bf16 v[44:47], v[80:83], v[64:67], v[44:47]
  ds_read_b64_tr_b16 v[120:121], v19 offset:10240
  s_add_u32 s48, s55, 32768
  s_add_u32 m0, s44, 4096
  s_nop 0
  buffer_load_dwordx4 v11, s[8:11], s48 offen lds
  ds_read_b64_tr_b16 v[122:123], v19 offset:10752
  v_mfma_f32_16x16x32_bf16 v[32:35], v[88:91], v[84:87], v[32:35]
  ds_read_b128 v[124:127], v15 offset:10240
  s_add_u32 s48, s55, 49152
  s_add_u32 m0, s44, 5120
  s_nop 0
  buffer_load_dwordx4 v12, s[8:11], s48 offen lds
  ds_read_b64_tr_b16 v[128:129], v16 offset:14336
  s_add_u32 s48, s55, 65536
  s_add_u32 m0, s44, 6144
  s_nop 0
  buffer_load_dwordx4 v11, s[8:11], s48 offen lds
  v_mfma_f32_16x16x32_bf16 v[36:39], v[92:95], v[84:87], v[36:39]
  ds_read_b64_tr_b16 v[130:131], v16 offset:14848
  ds_read_b64_tr_b16 v[132:133], v17 offset:14336
  s_add_u32 s48, s55, 81920
  s_add_u32 m0, s44, 7168
  s_nop 0
  buffer_load_dwordx4 v12, s[8:11], s48 offen lds
  v_mfma_f32_16x16x32_bf16 v[40:43], v[96:99], v[84:87], v[40:43]
  ds_read_b64_tr_b16 v[134:135], v17 offset:14848
  ds_read_b64_tr_b16 v[136:137], v18 offset:14336
  s_add_u32 s48, s55, 98304
  s_add_u32 m0, s44, 8192
  s_nop 0
  buffer_load_dwordx4 v11, s[8:11], s48 offen lds
  ds_read_b64_tr_b16 v[138:139], v18 offset:14848
  v_mfma_f32_16x16x32_bf16 v[44:47], v[100:103], v[84:87], v[44:47]
  ds_read_b64_tr_b16 v[140:141], v19 offset:14336
  s_add_u32 s48, s55, 114688
  s_add_u32 m0, s44, 9216
  s_nop 0
  buffer_load_dwordx4 v12, s[8:11], s48 offen lds
  ds_read_b64_tr_b16 v[142:143], v19 offset:14848
  s_waitcnt vmcnt(20) lgkmcnt(0)
  v_mfma_f32_16x16x32_bf16 v[32:35], v[108:111], v[104:107], v[32:35]
  ds_read_b128 v[64:67], v14 offset:20480
  s_add_u32 s53, s52, 13
  s_cmp_ge_u32 s53, 28
  s_cselect_b32 s54, 28, 0
  s_sub_u32 s53, s53, s54
  s_cmp_ge_u32 s53, 14
  s_cselect_b32 s54, 14, 0
  s_sub_u32 s53, s53, s54
  s_lshl_b32 s54, s53, 7
  s_lshl_b32 s55, s53, 17
  s_add_u32 s48, s54, 0
  s_add_u32 m0, s44, 10240
  s_nop 0
  buffer_load_dwordx4 v10, s[4:7], s48 offen lds
  ds_read_b64_tr_b16 v[68:69], v16 offset:20480
  s_add_u32 s48, s54, 57344
  s_add_u32 m0, s44, 11264
  s_nop 0
  buffer_load_dwordx4 v10, s[4:7], s48 offen lds
  v_mfma_f32_16x16x32_bf16 v[36:39], v[112:115], v[104:107], v[36:39]
  ds_read_b64_tr_b16 v[70:71], v16 offset:20992
  ds_read_b64_tr_b16 v[72:73], v17 offset:20480
  s_add_u32 s48, s55, 0
  s_add_u32 m0, s44, 12288
  s_nop 0
  buffer_load_dwordx4 v11, s[8:11], s48 offen lds
  v_mfma_f32_16x16x32_bf16 v[40:43], v[116:119], v[104:107], v[40:43]
  ds_read_b64_tr_b16 v[74:75], v17 offset:20992
  ds_read_b64_tr_b16 v[76:77], v18 offset:20480
  s_add_u32 s48, s55, 16384
  s_add_u32 m0, s44, 13312
  s_nop 0
  buffer_load_dwordx4 v12, s[8:11], s48 offen lds
  ds_read_b64_tr_b16 v[78:79], v18 offset:20992
  v_mfma_f32_16x16x32_bf16 v[44:47], v[120:123], v[104:107], v[44:47]
  ds_read_b64_tr_b16 v[80:81], v19 offset:20480
  s_add_u32 s48, s55, 32768
  s_add_u32 m0, s44, 14336
  s_nop 0
  buffer_load_dwordx4 v11, s[8:11], s48 offen lds
  ds_read_b64_tr_b16 v[82:83], v19 offset:20992
  v_mfma_f32_16x16x32_bf16 v[32:35], v[128:131], v[124:127], v[32:35]
  ds_read_b128 v[84:87], v15 offset:20480
  s_add_u32 s48, s55, 49152
  s_add_u32 m0, s44, 15360
  s_nop 0
  buffer_load_dwordx4 v12, s[8:11], s48 offen lds
  ds_read_b64_tr_b16 v[88:89], v16 offset:24576
  s_add_u32 s48, s55, 65536
  s_add_u32 m0, s44, 16384
  s_nop 0
  buffer_load_dwordx4 v11, s[8:11], s48 offen lds
  v_mfma_f32_16x16x32_bf16 v[36:39], v[132:135], v[124:127], v[36:39]
  ds_read_b64_tr_b16 v[90:91], v16 offset:25088
  ds_read_b64_tr_b16 v[92:93], v17 offset:24576
  s_add_u32 s48, s55, 81920
  s_add_u32 m0, s44, 17408
  s_nop 0
  buffer_load_dwordx4 v12, s[8:11], s48 offen lds
  v_mfma_f32_16x16x32_bf16 v[40:43], v[136:139], v[124:127], v[40:43]
  ds_read_b64_tr_b16 v[94:95], v17 offset:25088
  ds_read_b64_tr_b16 v[96:97], v18 offset:24576
  s_add_u32 s48, s55, 98304
  s_add_u32 m0, s44, 18432
  s_nop 0
  buffer_load_dwordx4 v11, s[8:11], s48 offen lds
  ds_read_b64_tr_b16 v[98:99], v18 offset:25088
  v_mfma_f32_16x16x32_bf16 v[44:47], v[140:143], v[124:127], v[44:47]
  ds_read_b64_tr_b16 v[100:101], v19 offset:24576
  s_add_u32 s48, s55, 114688
  s_add_u32 m0, s44, 19456
  s_nop 0
  buffer_load_dwordx4 v12, s[8:11], s48 offen lds
  ds_read_b64_tr_b16 v[102:103], v19 offset:25088
  s_waitcnt vmcnt(20) lgkmcnt(0)
  v_mfma_f32_16x16x32_bf16 v[32:35], v[68:71], v[64:67], v[32:35]
  ds_read_b128 v[104:107], v14 offset:30720
  ds_read_b64_tr_b16 v[108:109], v16 offset:30720
  ds_read_b64_tr_b16 v[110:111], v16 offset:31232
  v_mfma_f32_16x16x32_bf16 v[36:39], v[72:75], v[64:67], v[36:39]
  ds_read_b64_tr_b16 v[112:113], v17 offset:30720
  ds_read_b64_tr_b16 v[114:115], v17 offset:31232
  v_mfma_f32_16x16x32_bf16 v[40:43], v[76:79], v[64:67], v[40:43]
  ds_read_b64_tr_b16 v[116:117], v18 offset:30720
  ds_read_b64_tr_b16 v[118:119], v18 offset:31232
  v_mfma_f32_16x16x32_bf16 v[44:47], v[80:83], v[64:67], v[44:47]
  ds_read_b64_tr_b16 v[120:121], v19 offset:30720
  ds_read_b64_tr_b16 v[122:123], v19 offset:31232
  v_mfma_f32_16x16x32_bf16 v[32:35], v[88:91], v[84:87], v[32:35]
  ds_read_b128 v[124:127], v15 offset:30720
  ds_read_b64_tr_b16 v[128:129], v16 offset:34816
  ds_read_b64_tr_b16 v[130:131], v16 offset:35328
  v_mfma_f32_16x16x32_bf16 v[36:39], v[92:95], v[84:87], v[36:39]
  ds_read_b64_tr_b16 v[132:133], v17 offset:34816
  ds_read_b64_tr_b16 v[134:135], v17 offset:35328
  v_mfma_f32_16x16x32_bf16 v[40:43], v[96:99], v[84:87], v[40:43]
  ds_read_b64_tr_b16 v[136:137], v18 offset:34816
  ds_read_b64_tr_b16 v[138:139], v18 offset:35328
  v_mfma_f32_16x16x32_bf16 v[44:47], v[100:103], v[84:87], v[44:47]
  ds_read_b64_tr_b16 v[140:141], v19 offset:34816
  ds_read_b64_tr_b16 v[142:143], v19 offset:35328
  s_waitcnt vmcnt(10) lgkmcnt(0)
  v_mfma_f32_16x16x32_bf16 v[32:35], v[108:111], v[104:107], v[32:35]
  ds_read_b128 v[64:67], v14 offset:0
  ds_read_b64_tr_b16 v[68:69], v16 offset:0
  ds_read_b64_tr_b16 v[70:71], v16 offset:512
  v_mfma_f32_16x16x32_bf16 v[36:39], v[112:115], v[104:107], v[36:39]
  ds_read_b64_tr_b16 v[72:73], v17 offset:0
  ds_read_b64_tr_b16 v[74:75], v17 offset:512
  v_mfma_f32_16x16x32_bf16 v[40:43], v[116:119], v[104:107], v[40:43]
  ds_read_b64_tr_b16 v[76:77], v18 offset:0
  ds_read_b64_tr_b16 v[78:79], v18 offset:512
  v_mfma_f32_16x16x32_bf16 v[44:47], v[120:123], v[104:107], v[44:47]
  ds_read_b64_tr_b16 v[80:81], v19 offset:0
  ds_read_b64_tr_b16 v[82:83], v19 offset:512
  v_mfma_f32_16x16x32_bf16 v[32:35], v[128:131], v[124:127], v[32:35]
  ds_read_b128 v[84:87], v15 offset:0
  ds_read_b64_tr_b16 v[88:89], v16 offset:4096
  ds_read_b64_tr_b16 v[90:91], v16 offset:4608
  v_mfma_f32_16x16x32_bf16 v[36:39], v[132:135], v[124:127], v[36:39]
  ds_read_b64_tr_b16 v[92:93], v17 offset:4096
  ds_read_b64_tr_b16 v[94:95], v17 offset:4608
  v_mfma_f32_16x16x32_bf16 v[40:43], v[136:139], v[124:127], v[40:43]
  ds_read_b64_tr_b16 v[96:97], v18 offset:4096
  ds_read_b64_tr_b16 v[98:99], v18 offset:4608
  v_mfma_f32_16x16x32_bf16 v[44:47], v[140:143], v[124:127], v[44:47]
  ds_read_b64_tr_b16 v[100:101], v19 offset:4096
  ds_read_b64_tr_b16 v[102:103], v19 offset:4608
  s_waitcnt vmcnt(0) lgkmcnt(0)
  v_mfma_f32_16x16x32_bf16 v[32:35], v[68:71], v[64:67], v[32:35]
  ds_read_b128 v[104:107], v14 offset:10240
  ds_read_b64_tr_b16 v[108:109], v16 offset:10240
  ds_read_b64_tr_b16 v[110:111], v16 offset:10752
  v_mfma_f32_16x16x32_bf16 v[36:39], v[72:75], v[64:67], v[36:39]
  ds_read_b64_tr_b16 v[112:113], v17 offset:10240
  ds_read_b64_tr_b16 v[114:115], v17 offset:10752
  v_mfma_f32_16x16x32_bf16 v[40:43], v[76:79], v[64:67], v[40:43]
  ds_read_b64_tr_b16 v[116:117], v18 offset:10240
  ds_read_b64_tr_b16 v[118:119], v18 offset:10752
  v_mfma_f32_16x16x32_bf16 v[44:47], v[80:83], v[64:67], v[44:47]
  ds_read_b64_tr_b16 v[120:121], v19 offset:10240
  ds_read_b64_tr_b16 v[122:123], v19 offset:10752
  v_mfma_f32_16x16x32_bf16 v[32:35], v[88:91], v[84:87], v[32:35]
  ds_read_b128 v[124:127], v15 offset:10240
  ds_read_b64_tr_b16 v[128:129], v16 offset:14336
  ds_read_b64_tr_b16 v[130:131], v16 offset:14848
  v_mfma_f32_16x16x32_bf16 v[36:39], v[92:95], v[84:87], v[36:39]
  ds_read_b64_tr_b16 v[132:133], v17 offset:14336
  ds_read_b64_tr_b16 v[134:135], v17 offset:14848
  v_mfma_f32_16x16x32_bf16 v[40:43], v[96:99], v[84:87], v[40:43]
  ds_read_b64_tr_b16 v[136:137], v18 offset:14336
  ds_read_b64_tr_b16 v[138:139], v18 offset:14848
  v_mfma_f32_16x16x32_bf16 v[44:47], v[100:103], v[84:87], v[44:47]
  ds_read_b64_tr_b16 v[140:141], v19 offset:14336
  ds_read_b64_tr_b16 v[142:143], v19 offset:14848
  s_waitcnt lgkmcnt(0)
  v_mfma_f32_16x16x32_bf16 v[32:35], v[108:111], v[104:107], v[32:35]
  v_mfma_f32_16x16x32_bf16 v[36:39], v[112:115], v[104:107], v[36:39]
  v_mfma_f32_16x16x32_bf16 v[40:43], v[116:119], v[104:107], v[40:43]
  v_mfma_f32_16x16x32_bf16 v[44:47], v[120:123], v[104:107], v[44:47]
  v_mfma_f32_16x16x32_bf16 v[32:35], v[128:131], v[124:127], v[32:35]
  v_mfma_f32_16x16x32_bf16 v[36:39], v[132:135], v[124:127], v[36:39]
  v_mfma_f32_16x16x32_bf16 v[40:43], v[136:139], v[124:127], v[40:43]
  v_mfma_f32_16x16x32_bf16 v[44:47], v[140:143], v[124:127], v[44:47]
  v_lshlrev_b32 v18, 4, v1
  v_add_u32 v19, s44, v18
  s_lshl_b32 s45, s39, 10
  v_add_u32 v20, s45, v18
  v_add_u32 v21, 81920, v20
  v_and_b32 v5, 15, v1
  v_add_u32 v5, s37, v5
  v_lshlrev_b32 v5, 11, v5
  s_lshl_b32 s46, s39, 5
  s_add_u32 s46, s46, s43
  v_lshrrev_b32 v6, 4, v1
  v_lshlrev_b32 v6, 3, v6
  v_add_u32 v6, s46, v6
  v_add_u32 v5, v5, v6
  s_nop 7
  ds_write_b128 v19, v[32:35] offset:0
  ds_write_b128 v19, v[36:39] offset:1024
  ds_write_b128 v19, v[40:43] offset:2048
  ds_write_b128 v19, v[44:47] offset:3072
  s_waitcnt lgkmcnt(0)
  s_barrier
  ds_read_b128 v[64:67], v20 offset:0
  ds_read_b128 v[68:71], v20 offset:40960
  ds_read_b128 v[72:75], v21 offset:0
  ds_read_b128 v[76:79], v21 offset:40960
  s_waitcnt lgkmcnt(0)
  v_add_f32 v64, v64, v68
  v_add_f32 v72, v72, v76
  v_add_f32 v65, v65, v69
  v_add_f32 v73, v73, v77
  v_add_f32 v66, v66, v70
  v_add_f32 v74, v74, v78
  v_add_f32 v67, v67, v71
  v_add_f32 v75, v75, v79
  v_add_f32 v64, v64, v72
  v_add_f32 v65, v65, v73
  v_add_f32 v66, v66, v74
  v_add_f32 v67, v67, v75
  v_cvt_pk_bf16_f32 v80, v64, v65
  v_cvt_pk_bf16_f32 v81, v66, v67
  buffer_store_dwordx2 v[80:81], v5, s[16:19], 0 offen
L_k2_end:
  s_endpgm
.section .rodata,"a"
.p2align 6
.amdhsa_kernel ffn_up_kernel
  .amdhsa_next_free_vgpr 160
  .amdhsa_next_free_sgpr 64
  .amdhsa_accum_offset 160
  .amdhsa_group_segment_fixed_size 0
  .amdhsa_kernarg_size 56
  .amdhsa_user_sgpr_count 2
  .amdhsa_user_sgpr_kernarg_segment_ptr 1
  .amdhsa_system_sgpr_workgroup_id_x 1
.end_amdhsa_kernel
.p2align 6
.amdhsa_kernel ffn_down_kernel
  .amdhsa_next_free_vgpr 144
  .amdhsa_next_free_sgpr 64
  .amdhsa_accum_offset 144
  .amdhsa_group_segment_fixed_size 0
  .amdhsa_kernarg_size 56
  .amdhsa_user_sgpr_count 2
  .amdhsa_user_sgpr_kernarg_segment_ptr 1
  .amdhsa_system_sgpr_workgroup_id_x 1
.end_amdhsa_kernel
```
